```python
import torch

def _softmax(x, axis=-1):
    return torch.softmax(x, dim=axis)
def _gelu(x):
    return torch.nn.functional.gelu(x, approximate="tanh")
def _silu(x):
    return torch.nn.functional.silu(x)
def _sigmoid(x):
    return torch.sigmoid(x)
def _layernorm(x, axis=-1, eps=1e-5):
    m = x.mean(dim=axis, keepdim=True)
    v = x.var(dim=axis, keepdim=True, unbiased=False)
    return (x - m) / torch.sqrt(v + eps)
def _scatter_add(tgt, idx, src, axis=0):
    return tgt.clone().index_add_(axis, idx, src)
def _segment_sum(src, seg, n):
    out = torch.zeros((n,) + src.shape[1:], dtype=src.dtype)
    return out.index_add_(0, seg, src)
def _pad(x, pw):
    flat = tuple(v for pair in reversed(pw) for v in pair)
    return torch.nn.functional.pad(x, flat)

kernel_name = 'parallel_sum__mha_block_cached__geglu_ffn__decode'

def setup_inputs():

    _w = (lambda a: (lambda t: t.to(torch.bfloat16) if t.is_floating_point() else t)(torch.as_tensor(a)))
    def _A_setup():
        B, Sq, D = 2, 1, 640
        H, Sk, Dh = 32, 4096, 192
        return {
            "x": _w((lambda *s: torch.randn(*s, dtype=torch.bfloat16) * 0.05)(B, Sq, D)),
            "k_cache": _w((lambda *s: torch.randn(*s, dtype=torch.bfloat16) * 3.2)(B, H, Sk, Dh)),
            "v_cache": _w((lambda *s: torch.randn(*s, dtype=torch.bfloat16) * 1.6)(B, H, Sk, Dh)),
            "wq": _w((lambda *s: torch.randn(*s, dtype=torch.bfloat16) * 3.2)(D, H * Dh) * (D ** -0.5)),
            "wo": _w((lambda *s: torch.randn(*s, dtype=torch.bfloat16) * 1.6)(H * Dh, D) * ((H * Dh) ** -0.5)),
        }
    _A_in = _A_setup()

    def _B_setup():
        B, S, D, F = 2, 1, 640, 1536
        return {
            "x": _w((lambda *s: torch.randn(*s, dtype=torch.bfloat16) * 0.05)(B, S, D)),
            "w_gate": _w((lambda *s: torch.randn(*s, dtype=torch.bfloat16) * 0.05)(D, F)),
            "w_up": _w((lambda *s: torch.randn(*s, dtype=torch.bfloat16) * 0.05)(D, F)),
            "w_down": _w((lambda *s: torch.randn(*s, dtype=torch.bfloat16) * 0.05)(F, D)),
        }
    _B_in = _B_setup()

    return {
        "A_x": _A_in["x"],
        "A_k_cache": _A_in["k_cache"],
        "A_v_cache": _A_in["v_cache"],
        "A_wq": _A_in["wq"],
        "A_wo": _A_in["wo"],
        "B_x": _B_in["x"],
        "B_w_gate": _B_in["w_gate"],
        "B_w_up": _B_in["w_up"],
        "B_w_down": _B_in["w_down"],
    }

def reference(A_x, A_k_cache, A_v_cache, A_wq, A_wo, B_x, B_w_gate, B_w_up, B_w_down):
    def _A_ref(x, k_cache, v_cache, wq, wo):
        B, Sq, D = x.shape
        H, Dh = 32, 192
        q = (lambda x, *d: x.permute(*d))((x @ wq).reshape(B, Sq, H, Dh), 0, 2, 1, 3)
        scores = torch.einsum("bhqd,bhkd->bhqk", q, k_cache) * (Dh ** -0.5)
        p = _softmax(scores, axis=-1)
        o = torch.einsum("bhqk,bhkd->bhqd", p, v_cache)
        return (lambda x, *d: x.permute(*d))(o, 0, 2, 1, 3).reshape(B, Sq, H * Dh) @ wo

    def _B_ref(x, w_gate, w_up, w_down):
        return (_gelu(x @ w_gate) * (x @ w_up)) @ w_down

    x = A_x
    xn = _layernorm(x, axis=-1)
    return x + _A_ref(xn, A_k_cache, A_v_cache, A_wq, A_wo) + _B_ref(xn, B_w_gate, B_w_up, B_w_down)
```

```asm
; @launch grid=(256,1,1) block=(512,1,1) lds=12288
.amdgcn_target "amdgcn-amd-amdhsa--gfx950"
.text
.globl parallel_sum__mha_block_cached__geglu_ffn__decode_kernel
.p2align 8
.type parallel_sum__mha_block_cached__geglu_ffn__decode_kernel,@function
parallel_sum__mha_block_cached__geglu_ffn__decode_kernel:
    s_cmp_ge_u32 s2, 256
    s_cbranch_scc1 L_end
    s_load_dwordx16 s[8:23], s[0:1], 0
    s_load_dwordx8 s[24:31], s[0:1], 64
    v_lshrrev_b32 v1, 6, v0
    v_and_b32 v0, 63, v0
    v_readfirstlane_b32 s3, v1
    s_lshr_b32 s4, s2, 3
    s_and_b32 s5, s2, 7
    s_lshr_b32 s54, s4, 3
    s_lshl_b32 s52, s5, 2
    s_add_u32 s54, s54, s52
    s_and_b32 s52, s4, 7
    s_lshl_b32 s63, s54, 3
    s_add_u32 s63, s63, s52
    s_lshr_b32 s56, s52, 2
    v_lshrrev_b32 v2, 4, v0
    v_and_b32 v3, 15, v0
    s_cmp_ge_u32 s3, 4
    s_cbranch_scc1 L_T
    s_setprio 3
    s_cmp_eq_u32 s3, 3
    s_cbranch_scc1 L_S3
    v_lshrrev_b32 v58, 3, v3
    v_mul_u32_u24 v58, 1280, v58
    v_and_b32 v59, 7, v3
    v_mul_u32_u24 v30, 40, v59
    v_mul_u32_u24 v31, 320, v2
    v_add3_u32 v30, v30, v31, v58
    v_mul_u32_u24 v31, 40, v2
    s_mul_i32 s57, s5, 160
    v_add3_u32 v31, v31, v58, s57
    s_waitcnt lgkmcnt(0)
    s_load_dword s6, s[30:31], 0
    s_mov_b32 s36, s8
    s_mov_b32 s37, s9
    s_mov_b32 s38, 2560
    s_mov_b32 s39, 0x00020000
    buffer_load_dwordx4 v[8:11], v30, s[36:39], 0 offen
    buffer_load_dwordx4 v[12:15], v30, s[36:39], 0 offen offset:16
    buffer_load_dwordx2 v[16:17], v30, s[36:39], 0 offen offset:32
    buffer_load_dwordx4 v[20:23], v31, s[36:39], 0 offen
    buffer_load_dwordx4 v[24:27], v31, s[36:39], 0 offen offset:16
    buffer_load_dwordx2 v[28:29], v31, s[36:39], 0 offen offset:32
    s_cmp_eq_u32 s3, 2
    s_cbranch_scc1 L_S2
    s_mul_i32 s57, s5, 983040
    s_mul_i32 s58, s4, 384
    s_add_u32 s57, s57, s58
    s_mul_i32 s58, s3, 192
    s_add_u32 s57, s57, s58
    s_add_u32 s32, s14, s57
    s_addc_u32 s33, s15, 0
    s_mov_b32 s34, 983040
    s_mov_b32 s35, 0x00020000
    v_mul_u32_u24 v7, 245760, v2
    v_mul_u32_u24 v60, 12, v3
    v_add_u32 v7, v7, v60
    s_mov_b32 s44, 0
    buffer_load_dwordx3 v[64:66], v7, s[32:35], s44 offen nt
    s_mov_b32 s44, 12288
    buffer_load_dwordx3 v[68:70], v7, s[32:35], s44 offen nt
    s_mov_b32 s44, 24576
    buffer_load_dwordx3 v[72:74], v7, s[32:35], s44 offen nt
    s_mov_b32 s44, 36864
    buffer_load_dwordx3 v[76:78], v7, s[32:35], s44 offen nt
    s_mov_b32 s44, 49152
    buffer_load_dwordx3 v[80:82], v7, s[32:35], s44 offen nt
    s_mov_b32 s44, 61440
    buffer_load_dwordx3 v[84:86], v7, s[32:35], s44 offen nt
    s_mov_b32 s44, 73728
    buffer_load_dwordx3 v[88:90], v7, s[32:35], s44 offen nt
    s_mov_b32 s44, 86016
    buffer_load_dwordx3 v[92:94], v7, s[32:35], s44 offen nt
    s_mov_b32 s44, 98304
    buffer_load_dwordx3 v[96:98], v7, s[32:35], s44 offen nt
    s_mov_b32 s44, 110592
    buffer_load_dwordx3 v[100:102], v7, s[32:35], s44 offen nt
    s_mov_b32 s44, 122880
    buffer_load_dwordx3 v[104:106], v7, s[32:35], s44 offen nt
    s_mov_b32 s44, 135168
    buffer_load_dwordx3 v[108:110], v7, s[32:35], s44 offen nt
    s_mov_b32 s44, 147456
    buffer_load_dwordx3 v[112:114], v7, s[32:35], s44 offen nt
    s_mov_b32 s44, 159744
    buffer_load_dwordx3 v[116:118], v7, s[32:35], s44 offen nt
    s_mov_b32 s44, 172032
    buffer_load_dwordx3 v[120:122], v7, s[32:35], s44 offen nt
    s_mov_b32 s44, 184320
    buffer_load_dwordx3 v[124:126], v7, s[32:35], s44 offen nt
    s_mov_b32 s44, 196608
    buffer_load_dwordx3 v[128:130], v7, s[32:35], s44 offen nt
    s_mov_b32 s44, 208896
    buffer_load_dwordx3 v[132:134], v7, s[32:35], s44 offen nt
    s_mov_b32 s44, 221184
    buffer_load_dwordx3 v[136:138], v7, s[32:35], s44 offen nt
    s_mov_b32 s44, 233472
    buffer_load_dwordx3 v[140:142], v7, s[32:35], s44 offen nt
    s_barrier
    s_mov_b32 s40, s30
    s_mov_b32 s41, s31
    s_mov_b32 s42, 4194304
    s_mov_b32 s43, 0x00020000
    v_and_b32 v60, 7, v3
    v_lshrrev_b32 v61, 2, v60
    v_sub_u32 v61, v60, v61
    v_and_b32 v60, 3, v60
    v_cmp_eq_u32 vcc, 3, v60
    v_mov_b32 v60, 7
    s_nop 0
    v_cndmask_b32 v61, v61, v60, vcc
    v_and_b32 v60, 1, v61
    v_cmp_eq_u32 vcc, 1, v60
    v_mov_b32 v62, 0xffff
    v_mov_b32 v60, 0xffff0000
    v_cndmask_b32 v62, v62, v60, vcc
    v_lshrrev_b32 v61, 1, v61
    v_cmp_eq_u32 vcc, 0, v61
    s_nop 1
    v_cndmask_b32 v4, 0, v62, vcc
    v_cmp_eq_u32 vcc, 1, v61
    s_nop 1
    v_cndmask_b32 v5, 0, v62, vcc
    v_cmp_eq_u32 vcc, 2, v61
    s_nop 1
    v_cndmask_b32 v6, 0, v62, vcc
    v_mov_b32 v67, 0
    v_mov_b32 v147, 0
    v_mov_b32 v71, 0
    v_mov_b32 v151, 0
    v_mov_b32 v75, 0
    v_mov_b32 v155, 0
    v_mov_b32 v79, 0
    v_mov_b32 v159, 0
    v_mov_b32 v83, 0
    v_mov_b32 v163, 0
    v_mov_b32 v87, 0
    v_mov_b32 v167, 0
    v_mov_b32 v91, 0
    v_mov_b32 v171, 0
    v_mov_b32 v95, 0
    v_mov_b32 v175, 0
    v_mov_b32 v99, 0
    v_mov_b32 v179, 0
    v_mov_b32 v103, 0
    v_mov_b32 v183, 0
    v_mov_b32 v107, 0
    v_mov_b32 v187, 0
    v_mov_b32 v111, 0
    v_mov_b32 v191, 0
    v_mov_b32 v115, 0
    v_mov_b32 v195, 0
    v_mov_b32 v119, 0
    v_mov_b32 v199, 0
    v_mov_b32 v123, 0
    v_mov_b32 v203, 0
    v_mov_b32 v127, 0
    v_mov_b32 v207, 0
    v_mov_b32 v131, 0
    v_mov_b32 v211, 0
    v_mov_b32 v135, 0
    v_mov_b32 v215, 0
    v_mov_b32 v139, 0
    v_mov_b32 v219, 0
    v_mov_b32 v143, 0
    v_mov_b32 v223, 0
    s_waitcnt vmcnt(23)
    v_lshlrev_b32 v32, 16, v8
    v_and_b32 v33, 0xffff0000, v8
    v_lshlrev_b32 v34, 16, v9
    v_and_b32 v35, 0xffff0000, v9
    v_lshlrev_b32 v36, 16, v10
    v_and_b32 v37, 0xffff0000, v10
    v_lshlrev_b32 v38, 16, v11
    v_and_b32 v39, 0xffff0000, v11
    v_lshlrev_b32 v40, 16, v12
    v_and_b32 v41, 0xffff0000, v12
    v_lshlrev_b32 v42, 16, v13
    v_and_b32 v43, 0xffff0000, v13
    v_lshlrev_b32 v44, 16, v14
    v_and_b32 v45, 0xffff0000, v14
    v_lshlrev_b32 v46, 16, v15
    v_and_b32 v47, 0xffff0000, v15
    v_lshlrev_b32 v48, 16, v16
    v_and_b32 v49, 0xffff0000, v16
    v_lshlrev_b32 v50, 16, v17
    v_and_b32 v51, 0xffff0000, v17
    v_pk_add_f32 v[52:53], v[32:33], v[34:35]
    v_pk_add_f32 v[54:55], v[36:37], v[38:39]
    v_pk_add_f32 v[52:53], v[52:53], v[40:41]
    v_pk_add_f32 v[54:55], v[54:55], v[42:43]
    v_pk_add_f32 v[52:53], v[52:53], v[44:45]
    v_pk_add_f32 v[54:55], v[54:55], v[46:47]
    v_pk_add_f32 v[52:53], v[52:53], v[48:49]
    v_pk_add_f32 v[54:55], v[54:55], v[50:51]
    v_pk_add_f32 v[52:53], v[52:53], v[54:55]
    v_add_f32 v52, v52, v53
    s_nop 1
    v_add_f32_dpp v52, v52, v52 quad_perm:[1,0,3,2] row_mask:0xf bank_mask:0xf
    s_nop 1
    v_add_f32_dpp v52, v52, v52 quad_perm:[2,3,0,1] row_mask:0xf bank_mask:0xf
    s_nop 1
    v_add_f32_dpp v52, v52, v52 row_half_mirror row_mask:0xf bank_mask:0xf
    v_mov_b32 v53, v52
    s_nop 1
    v_permlane16_swap_b32 v52, v53
    v_add_f32 v52, v52, v53
    v_mov_b32 v53, v52
    s_nop 1
    v_permlane32_swap_b32 v52, v53
    v_add_f32 v52, v52, v53
    v_mul_f32 v52, 0x3acccccd, v52
    v_sub_f32 v54, 0, v52
    v_pk_add_f32 v[32:33], v[32:33], v[54:55] op_sel_hi:[1,0]
    v_pk_add_f32 v[34:35], v[34:35], v[54:55] op_sel_hi:[1,0]
    v_pk_add_f32 v[36:37], v[36:37], v[54:55] op_sel_hi:[1,0]
    v_pk_add_f32 v[38:39], v[38:39], v[54:55] op_sel_hi:[1,0]
    v_pk_add_f32 v[40:41], v[40:41], v[54:55] op_sel_hi:[1,0]
    v_pk_add_f32 v[42:43], v[42:43], v[54:55] op_sel_hi:[1,0]
    v_pk_add_f32 v[44:45], v[44:45], v[54:55] op_sel_hi:[1,0]
    v_pk_add_f32 v[46:47], v[46:47], v[54:55] op_sel_hi:[1,0]
    v_pk_add_f32 v[48:49], v[48:49], v[54:55] op_sel_hi:[1,0]
    v_pk_add_f32 v[50:51], v[50:51], v[54:55] op_sel_hi:[1,0]
    v_pk_mul_f32 v[56:57], v[32:33], v[32:33]
    v_pk_mul_f32 v[58:59], v[34:35], v[34:35]
    v_pk_fma_f32 v[56:57], v[36:37], v[36:37], v[56:57]
    v_pk_fma_f32 v[58:59], v[38:39], v[38:39], v[58:59]
    v_pk_fma_f32 v[56:57], v[40:41], v[40:41], v[56:57]
    v_pk_fma_f32 v[58:59], v[42:43], v[42:43], v[58:59]
    v_pk_fma_f32 v[56:57], v[44:45], v[44:45], v[56:57]
    v_pk_fma_f32 v[58:59], v[46:47], v[46:47], v[58:59]
    v_pk_fma_f32 v[56:57], v[48:49], v[48:49], v[56:57]
    v_pk_fma_f32 v[58:59], v[50:51], v[50:51], v[58:59]
    v_pk_add_f32 v[56:57], v[56:57], v[58:59]
    v_add_f32 v56, v56, v57
    s_nop 1
    v_add_f32_dpp v56, v56, v56 quad_perm:[1,0,3,2] row_mask:0xf bank_mask:0xf
    s_nop 1
    v_add_f32_dpp v56, v56, v56 quad_perm:[2,3,0,1] row_mask:0xf bank_mask:0xf
    s_nop 1
    v_add_f32_dpp v56, v56, v56 row_half_mirror row_mask:0xf bank_mask:0xf
    v_mov_b32 v57, v56
    s_nop 1
    v_permlane16_swap_b32 v56, v57
    v_add_f32 v56, v56, v57
    v_mov_b32 v57, v56
    s_nop 1
    v_permlane32_swap_b32 v56, v57
    v_add_f32 v56, v56, v57
    v_mul_f32 v56, 0x3acccccd, v56
    v_cvt_pk_bf16_f32 v56, v56, v56
    v_and_b32 v56, 0xffff0000, v56
    v_add_f32 v56, 0x3727c5ac, v56
    v_cvt_pk_bf16_f32 v56, v56, v56
    v_and_b32 v56, 0xffff0000, v56
    v_sqrt_f32 v56, v56
    s_nop 0
    v_cvt_pk_bf16_f32 v56, v56, v56
    v_and_b32 v56, 0xffff0000, v56
    v_rcp_f32 v56, v56
    v_cvt_pk_bf16_f32 v54, v52, v52
    v_and_b32 v54, 0xffff0000, v54
    v_sub_f32 v54, 0, v54
    s_waitcnt vmcnt(20)
    v_lshlrev_b32 v32, 16, v20
    v_and_b32 v33, 0xffff0000, v20
    v_lshlrev_b32 v34, 16, v21
    v_and_b32 v35, 0xffff0000, v21
    v_lshlrev_b32 v36, 16, v22
    v_and_b32 v37, 0xffff0000, v22
    v_lshlrev_b32 v38, 16, v23
    v_and_b32 v39, 0xffff0000, v23
    v_lshlrev_b32 v40, 16, v24
    v_and_b32 v41, 0xffff0000, v24
    v_lshlrev_b32 v42, 16, v25
    v_and_b32 v43, 0xffff0000, v25
    v_lshlrev_b32 v44, 16, v26
    v_and_b32 v45, 0xffff0000, v26
    v_lshlrev_b32 v46, 16, v27
    v_and_b32 v47, 0xffff0000, v27
    v_lshlrev_b32 v48, 16, v28
    v_and_b32 v49, 0xffff0000, v28
    v_lshlrev_b32 v50, 16, v29
    v_and_b32 v51, 0xffff0000, v29
    v_pk_add_f32 v[32:33], v[32:33], v[54:55] op_sel_hi:[1,0]
    v_pk_add_f32 v[34:35], v[34:35], v[54:55] op_sel_hi:[1,0]
    v_pk_add_f32 v[36:37], v[36:37], v[54:55] op_sel_hi:[1,0]
    v_pk_add_f32 v[38:39], v[38:39], v[54:55] op_sel_hi:[1,0]
    v_pk_add_f32 v[40:41], v[40:41], v[54:55] op_sel_hi:[1,0]
    v_pk_add_f32 v[42:43], v[42:43], v[54:55] op_sel_hi:[1,0]
    v_pk_add_f32 v[44:45], v[44:45], v[54:55] op_sel_hi:[1,0]
    v_pk_add_f32 v[46:47], v[46:47], v[54:55] op_sel_hi:[1,0]
    v_pk_add_f32 v[48:49], v[48:49], v[54:55] op_sel_hi:[1,0]
    v_pk_add_f32 v[50:51], v[50:51], v[54:55] op_sel_hi:[1,0]
    v_cvt_pk_bf16_f32 v8, v32, v33
    v_cvt_pk_bf16_f32 v9, v34, v35
    v_cvt_pk_bf16_f32 v10, v36, v37
    v_cvt_pk_bf16_f32 v11, v38, v39
    v_cvt_pk_bf16_f32 v12, v40, v41
    v_cvt_pk_bf16_f32 v13, v42, v43
    v_cvt_pk_bf16_f32 v14, v44, v45
    v_cvt_pk_bf16_f32 v15, v46, v47
    v_cvt_pk_bf16_f32 v16, v48, v49
    v_cvt_pk_bf16_f32 v17, v50, v51
    v_lshlrev_b32 v32, 16, v8
    v_and_b32 v33, 0xffff0000, v8
    v_lshlrev_b32 v34, 16, v9
    v_and_b32 v35, 0xffff0000, v9
    v_lshlrev_b32 v36, 16, v10
    v_and_b32 v37, 0xffff0000, v10
    v_lshlrev_b32 v38, 16, v11
    v_and_b32 v39, 0xffff0000, v11
    v_lshlrev_b32 v40, 16, v12
    v_and_b32 v41, 0xffff0000, v12
    v_lshlrev_b32 v42, 16, v13
    v_and_b32 v43, 0xffff0000, v13
    v_lshlrev_b32 v44, 16, v14
    v_and_b32 v45, 0xffff0000, v14
    v_lshlrev_b32 v46, 16, v15
    v_and_b32 v47, 0xffff0000, v15
    v_lshlrev_b32 v48, 16, v16
    v_and_b32 v49, 0xffff0000, v16
    v_lshlrev_b32 v50, 16, v17
    v_and_b32 v51, 0xffff0000, v17
    v_pk_mul_f32 v[32:33], v[32:33], v[56:57] op_sel_hi:[1,0]
    v_pk_mul_f32 v[34:35], v[34:35], v[56:57] op_sel_hi:[1,0]
    v_pk_mul_f32 v[36:37], v[36:37], v[56:57] op_sel_hi:[1,0]
    v_pk_mul_f32 v[38:39], v[38:39], v[56:57] op_sel_hi:[1,0]
    v_pk_mul_f32 v[40:41], v[40:41], v[56:57] op_sel_hi:[1,0]
    v_pk_mul_f32 v[42:43], v[42:43], v[56:57] op_sel_hi:[1,0]
    v_pk_mul_f32 v[44:45], v[44:45], v[56:57] op_sel_hi:[1,0]
    v_pk_mul_f32 v[46:47], v[46:47], v[56:57] op_sel_hi:[1,0]
    v_pk_mul_f32 v[48:49], v[48:49], v[56:57] op_sel_hi:[1,0]
    v_pk_mul_f32 v[50:51], v[50:51], v[56:57] op_sel_hi:[1,0]
    v_cvt_pk_bf16_f32 v32, v32, v32
    v_cvt_pk_bf16_f32 v33, v33, v33
    v_cvt_pk_bf16_f32 v34, v34, v34
    v_cvt_pk_bf16_f32 v35, v35, v35
    v_cvt_pk_bf16_f32 v36, v36, v36
    v_cvt_pk_bf16_f32 v37, v37, v37
    v_cvt_pk_bf16_f32 v38, v38, v38
    v_cvt_pk_bf16_f32 v39, v39, v39
    v_cvt_pk_bf16_f32 v40, v40, v40
    v_cvt_pk_bf16_f32 v41, v41, v41
    v_cvt_pk_bf16_f32 v42, v42, v42
    v_cvt_pk_bf16_f32 v43, v43, v43
    v_cvt_pk_bf16_f32 v44, v44, v44
    v_cvt_pk_bf16_f32 v45, v45, v45
    v_cvt_pk_bf16_f32 v46, v46, v46
    v_cvt_pk_bf16_f32 v47, v47, v47
    v_cvt_pk_bf16_f32 v48, v48, v48
    v_cvt_pk_bf16_f32 v49, v49, v49
    v_cvt_pk_bf16_f32 v50, v50, v50
    v_cvt_pk_bf16_f32 v51, v51, v51
    v_and_b32 v144, v32, v4
    v_and_b32 v145, v32, v5
    v_and_b32 v146, v32, v6
    v_and_b32 v148, v33, v4
    v_and_b32 v149, v33, v5
    v_and_b32 v150, v33, v6
    v_and_b32 v152, v34, v4
    v_and_b32 v153, v34, v5
    v_and_b32 v154, v34, v6
    v_and_b32 v156, v35, v4
    v_and_b32 v157, v35, v5
    v_and_b32 v158, v35, v6
    v_and_b32 v160, v36, v4
    v_and_b32 v161, v36, v5
    v_and_b32 v162, v36, v6
    v_and_b32 v164, v37, v4
    v_and_b32 v165, v37, v5
    v_and_b32 v166, v37, v6
    v_and_b32 v168, v38, v4
    v_and_b32 v169, v38, v5
    v_and_b32 v170, v38, v6
    v_and_b32 v172, v39, v4
    v_and_b32 v173, v39, v5
    v_and_b32 v174, v39, v6
    v_and_b32 v176, v40, v4
    v_and_b32 v177, v40, v5
    v_and_b32 v178, v40, v6
    v_and_b32 v180, v41, v4
    v_and_b32 v181, v41, v5
    v_and_b32 v182, v41, v6
    v_and_b32 v184, v42, v4
    v_and_b32 v185, v42, v5
    v_and_b32 v186, v42, v6
    v_and_b32 v188, v43, v4
    v_and_b32 v189, v43, v5
    v_and_b32 v190, v43, v6
    v_and_b32 v192, v44, v4
    v_and_b32 v193, v44, v5
    v_and_b32 v194, v44, v6
    v_and_b32 v196, v45, v4
    v_and_b32 v197, v45, v5
    v_and_b32 v198, v45, v6
    v_and_b32 v200, v46, v4
    v_and_b32 v201, v46, v5
    v_and_b32 v202, v46, v6
    v_and_b32 v204, v47, v4
    v_and_b32 v205, v47, v5
    v_and_b32 v206, v47, v6
    v_and_b32 v208, v48, v4
    v_and_b32 v209, v48, v5
    v_and_b32 v210, v48, v6
    v_and_b32 v212, v49, v4
    v_and_b32 v213, v49, v5
    v_and_b32 v214, v49, v6
    v_and_b32 v216, v50, v4
    v_and_b32 v217, v50, v5
    v_and_b32 v218, v50, v6
    v_and_b32 v220, v51, v4
    v_and_b32 v221, v51, v5
    v_and_b32 v222, v51, v6
    s_waitcnt vmcnt(19)
    v_mfma_f32_16x16x32_bf16 v[224:227], v[144:147], v[64:67], 0
    s_waitcnt vmcnt(18)
    v_mfma_f32_16x16x32_bf16 v[224:227], v[148:151], v[68:71], v[224:227]
    s_waitcnt vmcnt(17)
    v_mfma_f32_16x16x32_bf16 v[224:227], v[152:155], v[72:75], v[224:227]
    s_waitcnt vmcnt(16)
    v_mfma_f32_16x16x32_bf16 v[224:227], v[156:159], v[76:79], v[224:227]
    s_waitcnt vmcnt(15)
    v_mfma_f32_16x16x32_bf16 v[224:227], v[160:163], v[80:83], v[224:227]
    s_waitcnt vmcnt(14)
    v_mfma_f32_16x16x32_bf16 v[224:227], v[164:167], v[84:87], v[224:227]
    s_waitcnt vmcnt(13)
    v_mfma_f32_16x16x32_bf16 v[224:227], v[168:171], v[88:91], v[224:227]
    s_waitcnt vmcnt(12)
    v_mfma_f32_16x16x32_bf16 v[224:227], v[172:175], v[92:95], v[224:227]
    s_waitcnt vmcnt(11)
    v_mfma_f32_16x16x32_bf16 v[224:227], v[176:179], v[96:99], v[224:227]
    s_waitcnt vmcnt(10)
    v_mfma_f32_16x16x32_bf16 v[224:227], v[180:183], v[100:103], v[224:227]
    s_waitcnt vmcnt(9)
    v_mfma_f32_16x16x32_bf16 v[224:227], v[184:187], v[104:107], v[224:227]
    s_waitcnt vmcnt(8)
    v_mfma_f32_16x16x32_bf16 v[224:227], v[188:191], v[108:111], v[224:227]
    s_waitcnt vmcnt(7)
    v_mfma_f32_16x16x32_bf16 v[224:227], v[192:195], v[112:115], v[224:227]
    s_waitcnt vmcnt(6)
    v_mfma_f32_16x16x32_bf16 v[224:227], v[196:199], v[116:119], v[224:227]
    s_waitcnt vmcnt(5)
    v_mfma_f32_16x16x32_bf16 v[224:227], v[200:203], v[120:123], v[224:227]
    s_waitcnt vmcnt(4)
    v_mfma_f32_16x16x32_bf16 v[224:227], v[204:207], v[124:127], v[224:227]
    s_waitcnt vmcnt(3)
    v_mfma_f32_16x16x32_bf16 v[224:227], v[208:211], v[128:131], v[224:227]
    s_waitcnt vmcnt(2)
    v_mfma_f32_16x16x32_bf16 v[224:227], v[212:215], v[132:135], v[224:227]
    s_waitcnt vmcnt(1)
    v_mfma_f32_16x16x32_bf16 v[224:227], v[216:219], v[136:139], v[224:227]
    s_waitcnt vmcnt(0)
    v_mfma_f32_16x16x32_bf16 v[224:227], v[220:223], v[140:143], v[224:227]
    s_waitcnt lgkmcnt(0)
    s_mul_i32 s7, s6, 0x9E3779B1
    s_add_u32 s7, s7, 0x7F4A7C15
    s_add_u32 s53, s6, 0x55
    s_and_b32 s53, s53, 0x7F
    s_or_b32 s53, s53, 0x80
    v_lshrrev_b32 v8, 1, v2
    v_lshlrev_b32 v8, 9, v8
    v_and_b32 v9, 1, v2
    v_lshl_add_u32 v9, v3, 1, v9
    v_lshl_add_u32 v8, v9, 4, v8
    s_lshl_b32 s44, s2, 11
    s_lshl_b32 s57, s3, 10
    s_add_u32 s44, s44, s57
    s_add_u32 s44, s44, 4096
    s_mov_b32 s62, s7
    v_mov_b32 v227, s62
    buffer_store_dwordx4 v[224:227], v8, s[40:43], s44 offen sc1
    v_lshrrev_b32 v9, 5, v0
    v_lshlrev_b32 v9, 11, v9
    v_and_b32 v10, 31, v0
    v_lshl_add_u32 v9, v10, 4, v9
    s_lshl_b32 s44, s54, 14
    s_add_u32 s44, s44, s57
    s_lshl_b32 s58, s56, 9
    s_add_u32 s44, s44, s58
    s_add_u32 s44, s44, 4096
    s_add_u32 s45, s44, 4096
    s_add_u32 s46, s44, 8192
    s_add_u32 s47, s44, 12288
    v_mul_u32_u24 v11, 6, v10
    v_lshrrev_b32 v28, 5, v0
    v_lshl_add_u32 v11, v28, 1, v11
    s_mul_i32 s58, s3, 192
    v_add_u32 v11, s58, v11
    s_mov_b32 s55, 200000
L_qpoll_1:
    buffer_load_dwordx4 v[12:15], v9, s[40:43], s44 offen sc1
    buffer_load_dwordx4 v[16:19], v9, s[40:43], s45 offen sc1
    buffer_load_dwordx4 v[20:23], v9, s[40:43], s46 offen sc1
    buffer_load_dwordx4 v[24:27], v9, s[40:43], s47 offen sc1
    s_waitcnt vmcnt(0)
    v_xor_b32 v28, s62, v15
    v_xor_b32 v29, s62, v19
    v_xor_b32 v30, s62, v23
    v_xor_b32 v31, s62, v27
    v_or3_b32 v28, v28, v29, v30
    v_or_b32 v28, v28, v31
    v_cmp_ne_u32 vcc, 0, v28
    s_cbranch_vccz L_done_2
    s_sub_u32 s55, s55, 1
    s_cbranch_scc0 L_qpoll_1
L_done_2:
    v_pk_add_f32 v[12:13], v[12:13], v[16:17]
    v_pk_add_f32 v[20:21], v[20:21], v[24:25]
    v_add_f32 v14, v14, v18
    v_add_f32 v22, v22, v26
    v_pk_add_f32 v[12:13], v[12:13], v[20:21]
    v_add_f32 v14, v14, v22
    s_nop 0
    v_permlane32_swap_b32 v12, v13
    v_mov_b32 v15, v14
    v_add_f32 v12, v12, v13
    s_nop 0
    v_permlane32_swap_b32 v14, v15
    v_add_f32 v14, v14, v15
    v_cvt_pk_bf16_f32 v12, v12, v14
    ds_write_b16 v11, v12 offset:0
    s_mov_b32 exec_hi, 0
    ds_write_b16_d16_hi v11, v12 offset:4
    s_mov_b32 exec_hi, -1
    s_waitcnt lgkmcnt(0)
    s_barrier
    s_branch L_Spost
L_S2:
    s_mul_i32 s57, s5, 245760
    s_mul_i32 s58, s4, 96
    s_add_u32 s57, s57, s58
    s_add_u32 s32, s20, s57
    s_addc_u32 s33, s21, 0
    s_mov_b32 s34, 245760
    s_mov_b32 s35, 0x00020000
    v_mul_u32_u24 v7, 61440, v2
    v_and_b32 v60, 7, v3
    v_mul_u32_u24 v60, 12, v60
    v_add_u32 v7, v7, v60
    s_add_u32 s36, s22, s57
    s_addc_u32 s37, s23, 0
    s_mov_b32 s38, 245760
    s_mov_b32 s39, 0x00020000
    s_mov_b32 s44, 0
    s_mov_b32 exec_lo, 0x00ff00ff
    s_mov_b32 exec_hi, 0x00ff00ff
    buffer_load_dwordx3 v[64:66], v7, s[32:35], s44 offen nt
    s_mov_b32 exec_lo, 0xff00ff00
    s_mov_b32 exec_hi, 0xff00ff00
    buffer_load_dwordx3 v[64:66], v7, s[36:39], s44 offen nt
    s_mov_b32 s44, 3072
    s_mov_b32 exec_lo, 0x00ff00ff
    s_mov_b32 exec_hi, 0x00ff00ff
    buffer_load_dwordx3 v[68:70], v7, s[32:35], s44 offen nt
    s_mov_b32 exec_lo, 0xff00ff00
    s_mov_b32 exec_hi, 0xff00ff00
    buffer_load_dwordx3 v[68:70], v7, s[36:39], s44 offen nt
    s_mov_b32 s44, 6144
    s_mov_b32 exec_lo, 0x00ff00ff
    s_mov_b32 exec_hi, 0x00ff00ff
    buffer_load_dwordx3 v[72:74], v7, s[32:35], s44 offen nt
    s_mov_b32 exec_lo, 0xff00ff00
    s_mov_b32 exec_hi, 0xff00ff00
    buffer_load_dwordx3 v[72:74], v7, s[36:39], s44 offen nt
    s_mov_b32 s44, 9216
    s_mov_b32 exec_lo, 0x00ff00ff
    s_mov_b32 exec_hi, 0x00ff00ff
    buffer_load_dwordx3 v[76:78], v7, s[32:35], s44 offen nt
    s_mov_b32 exec_lo, 0xff00ff00
    s_mov_b32 exec_hi, 0xff00ff00
    buffer_load_dwordx3 v[76:78], v7, s[36:39], s44 offen nt
    s_mov_b32 s44, 12288
    s_mov_b32 exec_lo, 0x00ff00ff
    s_mov_b32 exec_hi, 0x00ff00ff
    buffer_load_dwordx3 v[80:82], v7, s[32:35], s44 offen nt
    s_mov_b32 exec_lo, 0xff00ff00
    s_mov_b32 exec_hi, 0xff00ff00
    buffer_load_dwordx3 v[80:82], v7, s[36:39], s44 offen nt
    s_mov_b32 s44, 15360
    s_mov_b32 exec_lo, 0x00ff00ff
    s_mov_b32 exec_hi, 0x00ff00ff
    buffer_load_dwordx3 v[84:86], v7, s[32:35], s44 offen nt
    s_mov_b32 exec_lo, 0xff00ff00
    s_mov_b32 exec_hi, 0xff00ff00
    buffer_load_dwordx3 v[84:86], v7, s[36:39], s44 offen nt
    s_mov_b32 s44, 18432
    s_mov_b32 exec_lo, 0x00ff00ff
    s_mov_b32 exec_hi, 0x00ff00ff
    buffer_load_dwordx3 v[88:90], v7, s[32:35], s44 offen nt
    s_mov_b32 exec_lo, 0xff00ff00
    s_mov_b32 exec_hi, 0xff00ff00
    buffer_load_dwordx3 v[88:90], v7, s[36:39], s44 offen nt
    s_mov_b32 s44, 21504
    s_mov_b32 exec_lo, 0x00ff00ff
    s_mov_b32 exec_hi, 0x00ff00ff
    buffer_load_dwordx3 v[92:94], v7, s[32:35], s44 offen nt
    s_mov_b32 exec_lo, 0xff00ff00
    s_mov_b32 exec_hi, 0xff00ff00
    buffer_load_dwordx3 v[92:94], v7, s[36:39], s44 offen nt
    s_mov_b32 s44, 24576
    s_mov_b32 exec_lo, 0x00ff00ff
    s_mov_b32 exec_hi, 0x00ff00ff
    buffer_load_dwordx3 v[96:98], v7, s[32:35], s44 offen nt
    s_mov_b32 exec_lo, 0xff00ff00
    s_mov_b32 exec_hi, 0xff00ff00
    buffer_load_dwordx3 v[96:98], v7, s[36:39], s44 offen nt
    s_mov_b32 s44, 27648
    s_mov_b32 exec_lo, 0x00ff00ff
    s_mov_b32 exec_hi, 0x00ff00ff
    buffer_load_dwordx3 v[100:102], v7, s[32:35], s44 offen nt
    s_mov_b32 exec_lo, 0xff00ff00
    s_mov_b32 exec_hi, 0xff00ff00
    buffer_load_dwordx3 v[100:102], v7, s[36:39], s44 offen nt
    s_mov_b32 s44, 30720
    s_mov_b32 exec_lo, 0x00ff00ff
    s_mov_b32 exec_hi, 0x00ff00ff
    buffer_load_dwordx3 v[104:106], v7, s[32:35], s44 offen nt
    s_mov_b32 exec_lo, 0xff00ff00
    s_mov_b32 exec_hi, 0xff00ff00
    buffer_load_dwordx3 v[104:106], v7, s[36:39], s44 offen nt
    s_mov_b32 s44, 33792
    s_mov_b32 exec_lo, 0x00ff00ff
    s_mov_b32 exec_hi, 0x00ff00ff
    buffer_load_dwordx3 v[108:110], v7, s[32:35], s44 offen nt
    s_mov_b32 exec_lo, 0xff00ff00
    s_mov_b32 exec_hi, 0xff00ff00
    buffer_load_dwordx3 v[108:110], v7, s[36:39], s44 offen nt
    s_mov_b32 s44, 36864
    s_mov_b32 exec_lo, 0x00ff00ff
    s_mov_b32 exec_hi, 0x00ff00ff
    buffer_load_dwordx3 v[112:114], v7, s[32:35], s44 offen nt
    s_mov_b32 exec_lo, 0xff00ff00
    s_mov_b32 exec_hi, 0xff00ff00
    buffer_load_dwordx3 v[112:114], v7, s[36:39], s44 offen nt
    s_mov_b32 s44, 39936
    s_mov_b32 exec_lo, 0x00ff00ff
    s_mov_b32 exec_hi, 0x00ff00ff
    buffer_load_dwordx3 v[116:118], v7, s[32:35], s44 offen nt
    s_mov_b32 exec_lo, 0xff00ff00
    s_mov_b32 exec_hi, 0xff00ff00
    buffer_load_dwordx3 v[116:118], v7, s[36:39], s44 offen nt
    s_mov_b32 s44, 43008
    s_mov_b32 exec_lo, 0x00ff00ff
    s_mov_b32 exec_hi, 0x00ff00ff
    buffer_load_dwordx3 v[120:122], v7, s[32:35], s44 offen nt
    s_mov_b32 exec_lo, 0xff00ff00
    s_mov_b32 exec_hi, 0xff00ff00
    buffer_load_dwordx3 v[120:122], v7, s[36:39], s44 offen nt
    s_mov_b32 s44, 46080
    s_mov_b32 exec_lo, 0x00ff00ff
    s_mov_b32 exec_hi, 0x00ff00ff
    buffer_load_dwordx3 v[124:126], v7, s[32:35], s44 offen nt
    s_mov_b32 exec_lo, 0xff00ff00
    s_mov_b32 exec_hi, 0xff00ff00
    buffer_load_dwordx3 v[124:126], v7, s[36:39], s44 offen nt
    s_mov_b32 s44, 49152
    s_mov_b32 exec_lo, 0x00ff00ff
    s_mov_b32 exec_hi, 0x00ff00ff
    buffer_load_dwordx3 v[128:130], v7, s[32:35], s44 offen nt
    s_mov_b32 exec_lo, 0xff00ff00
    s_mov_b32 exec_hi, 0xff00ff00
    buffer_load_dwordx3 v[128:130], v7, s[36:39], s44 offen nt
    s_mov_b32 s44, 52224
    s_mov_b32 exec_lo, 0x00ff00ff
    s_mov_b32 exec_hi, 0x00ff00ff
    buffer_load_dwordx3 v[132:134], v7, s[32:35], s44 offen nt
    s_mov_b32 exec_lo, 0xff00ff00
    s_mov_b32 exec_hi, 0xff00ff00
    buffer_load_dwordx3 v[132:134], v7, s[36:39], s44 offen nt
    s_mov_b32 s44, 55296
    s_mov_b32 exec_lo, 0x00ff00ff
    s_mov_b32 exec_hi, 0x00ff00ff
    buffer_load_dwordx3 v[136:138], v7, s[32:35], s44 offen nt
    s_mov_b32 exec_lo, 0xff00ff00
    s_mov_b32 exec_hi, 0xff00ff00
    buffer_load_dwordx3 v[136:138], v7, s[36:39], s44 offen nt
    s_mov_b32 s44, 58368
    s_mov_b32 exec_lo, 0x00ff00ff
    s_mov_b32 exec_hi, 0x00ff00ff
    buffer_load_dwordx3 v[140:142], v7, s[32:35], s44 offen nt
    s_mov_b32 exec_lo, 0xff00ff00
    s_mov_b32 exec_hi, 0xff00ff00
    buffer_load_dwordx3 v[140:142], v7, s[36:39], s44 offen nt
    s_mov_b64 exec, -1
    s_barrier
    s_mov_b32 s40, s30
    s_mov_b32 s41, s31
    s_mov_b32 s42, 4194304
    s_mov_b32 s43, 0x00020000
    v_and_b32 v60, 7, v3
    v_lshrrev_b32 v61, 2, v60
    v_sub_u32 v61, v60, v61
    v_and_b32 v60, 3, v60
    v_cmp_eq_u32 vcc, 3, v60
    v_mov_b32 v60, 7
    s_nop 0
    v_cndmask_b32 v61, v61, v60, vcc
    v_and_b32 v60, 1, v61
    v_cmp_eq_u32 vcc, 1, v60
    v_mov_b32 v62, 0xffff
    v_mov_b32 v60, 0xffff0000
    v_cndmask_b32 v62, v62, v60, vcc
    v_lshrrev_b32 v61, 1, v61
    v_cmp_eq_u32 vcc, 0, v61
    s_nop 1
    v_cndmask_b32 v4, 0, v62, vcc
    v_cmp_eq_u32 vcc, 1, v61
    s_nop 1
    v_cndmask_b32 v5, 0, v62, vcc
    v_cmp_eq_u32 vcc, 2, v61
    s_nop 1
    v_cndmask_b32 v6, 0, v62, vcc
    v_mov_b32 v67, 0
    v_mov_b32 v147, 0
    v_mov_b32 v71, 0
    v_mov_b32 v151, 0
    v_mov_b32 v75, 0
    v_mov_b32 v155, 0
    v_mov_b32 v79, 0
    v_mov_b32 v159, 0
    v_mov_b32 v83, 0
    v_mov_b32 v163, 0
    v_mov_b32 v87, 0
    v_mov_b32 v167, 0
    v_mov_b32 v91, 0
    v_mov_b32 v171, 0
    v_mov_b32 v95, 0
    v_mov_b32 v175, 0
    v_mov_b32 v99, 0
    v_mov_b32 v179, 0
    v_mov_b32 v103, 0
    v_mov_b32 v183, 0
    v_mov_b32 v107, 0
    v_mov_b32 v187, 0
    v_mov_b32 v111, 0
    v_mov_b32 v191, 0
    v_mov_b32 v115, 0
    v_mov_b32 v195, 0
    v_mov_b32 v119, 0
    v_mov_b32 v199, 0
    v_mov_b32 v123, 0
    v_mov_b32 v203, 0
    v_mov_b32 v127, 0
    v_mov_b32 v207, 0
    v_mov_b32 v131, 0
    v_mov_b32 v211, 0
    v_mov_b32 v135, 0
    v_mov_b32 v215, 0
    v_mov_b32 v139, 0
    v_mov_b32 v219, 0
    v_mov_b32 v143, 0
    v_mov_b32 v223, 0
    s_waitcnt vmcnt(43)
    v_lshlrev_b32 v32, 16, v8
    v_and_b32 v33, 0xffff0000, v8
    v_lshlrev_b32 v34, 16, v9
    v_and_b32 v35, 0xffff0000, v9
    v_lshlrev_b32 v36, 16, v10
    v_and_b32 v37, 0xffff0000, v10
    v_lshlrev_b32 v38, 16, v11
    v_and_b32 v39, 0xffff0000, v11
    v_lshlrev_b32 v40, 16, v12
    v_and_b32 v41, 0xffff0000, v12
    v_lshlrev_b32 v42, 16, v13
    v_and_b32 v43, 0xffff0000, v13
    v_lshlrev_b32 v44, 16, v14
    v_and_b32 v45, 0xffff0000, v14
    v_lshlrev_b32 v46, 16, v15
    v_and_b32 v47, 0xffff0000, v15
    v_lshlrev_b32 v48, 16, v16
    v_and_b32 v49, 0xffff0000, v16
    v_lshlrev_b32 v50, 16, v17
    v_and_b32 v51, 0xffff0000, v17
    v_pk_add_f32 v[52:53], v[32:33], v[34:35]
    v_pk_add_f32 v[54:55], v[36:37], v[38:39]
    v_pk_add_f32 v[52:53], v[52:53], v[40:41]
    v_pk_add_f32 v[54:55], v[54:55], v[42:43]
    v_pk_add_f32 v[52:53], v[52:53], v[44:45]
    v_pk_add_f32 v[54:55], v[54:55], v[46:47]
    v_pk_add_f32 v[52:53], v[52:53], v[48:49]
    v_pk_add_f32 v[54:55], v[54:55], v[50:51]
    v_pk_add_f32 v[52:53], v[52:53], v[54:55]
    v_add_f32 v52, v52, v53
    s_nop 1
    v_add_f32_dpp v52, v52, v52 quad_perm:[1,0,3,2] row_mask:0xf bank_mask:0xf
    s_nop 1
    v_add_f32_dpp v52, v52, v52 quad_perm:[2,3,0,1] row_mask:0xf bank_mask:0xf
    s_nop 1
    v_add_f32_dpp v52, v52, v52 row_half_mirror row_mask:0xf bank_mask:0xf
    v_mov_b32 v53, v52
    s_nop 1
    v_permlane16_swap_b32 v52, v53
    v_add_f32 v52, v52, v53
    v_mov_b32 v53, v52
    s_nop 1
    v_permlane32_swap_b32 v52, v53
    v_add_f32 v52, v52, v53
    v_mul_f32 v52, 0x3acccccd, v52
    v_sub_f32 v54, 0, v52
    v_pk_add_f32 v[32:33], v[32:33], v[54:55] op_sel_hi:[1,0]
    v_pk_add_f32 v[34:35], v[34:35], v[54:55] op_sel_hi:[1,0]
    v_pk_add_f32 v[36:37], v[36:37], v[54:55] op_sel_hi:[1,0]
    v_pk_add_f32 v[38:39], v[38:39], v[54:55] op_sel_hi:[1,0]
    v_pk_add_f32 v[40:41], v[40:41], v[54:55] op_sel_hi:[1,0]
    v_pk_add_f32 v[42:43], v[42:43], v[54:55] op_sel_hi:[1,0]
    v_pk_add_f32 v[44:45], v[44:45], v[54:55] op_sel_hi:[1,0]
    v_pk_add_f32 v[46:47], v[46:47], v[54:55] op_sel_hi:[1,0]
    v_pk_add_f32 v[48:49], v[48:49], v[54:55] op_sel_hi:[1,0]
    v_pk_add_f32 v[50:51], v[50:51], v[54:55] op_sel_hi:[1,0]
    v_pk_mul_f32 v[56:57], v[32:33], v[32:33]
    v_pk_mul_f32 v[58:59], v[34:35], v[34:35]
    v_pk_fma_f32 v[56:57], v[36:37], v[36:37], v[56:57]
    v_pk_fma_f32 v[58:59], v[38:39], v[38:39], v[58:59]
    v_pk_fma_f32 v[56:57], v[40:41], v[40:41], v[56:57]
    v_pk_fma_f32 v[58:59], v[42:43], v[42:43], v[58:59]
    v_pk_fma_f32 v[56:57], v[44:45], v[44:45], v[56:57]
    v_pk_fma_f32 v[58:59], v[46:47], v[46:47], v[58:59]
    v_pk_fma_f32 v[56:57], v[48:49], v[48:49], v[56:57]
    v_pk_fma_f32 v[58:59], v[50:51], v[50:51], v[58:59]
    v_pk_add_f32 v[56:57], v[56:57], v[58:59]
    v_add_f32 v56, v56, v57
    s_nop 1
    v_add_f32_dpp v56, v56, v56 quad_perm:[1,0,3,2] row_mask:0xf bank_mask:0xf
    s_nop 1
    v_add_f32_dpp v56, v56, v56 quad_perm:[2,3,0,1] row_mask:0xf bank_mask:0xf
    s_nop 1
    v_add_f32_dpp v56, v56, v56 row_half_mirror row_mask:0xf bank_mask:0xf
    v_mov_b32 v57, v56
    s_nop 1
    v_permlane16_swap_b32 v56, v57
    v_add_f32 v56, v56, v57
    v_mov_b32 v57, v56
    s_nop 1
    v_permlane32_swap_b32 v56, v57
    v_add_f32 v56, v56, v57
    v_mul_f32 v56, 0x3acccccd, v56
    v_cvt_pk_bf16_f32 v56, v56, v56
    v_and_b32 v56, 0xffff0000, v56
    v_add_f32 v56, 0x3727c5ac, v56
    v_cvt_pk_bf16_f32 v56, v56, v56
    v_and_b32 v56, 0xffff0000, v56
    v_sqrt_f32 v56, v56
    s_nop 0
    v_cvt_pk_bf16_f32 v56, v56, v56
    v_and_b32 v56, 0xffff0000, v56
    v_rcp_f32 v56, v56
    v_cvt_pk_bf16_f32 v54, v52, v52
    v_and_b32 v54, 0xffff0000, v54
    v_sub_f32 v54, 0, v54
    s_waitcnt vmcnt(40)
    v_lshlrev_b32 v32, 16, v20
    v_and_b32 v33, 0xffff0000, v20
    v_lshlrev_b32 v34, 16, v21
    v_and_b32 v35, 0xffff0000, v21
    v_lshlrev_b32 v36, 16, v22
    v_and_b32 v37, 0xffff0000, v22
    v_lshlrev_b32 v38, 16, v23
    v_and_b32 v39, 0xffff0000, v23
    v_lshlrev_b32 v40, 16, v24
    v_and_b32 v41, 0xffff0000, v24
    v_lshlrev_b32 v42, 16, v25
    v_and_b32 v43, 0xffff0000, v25
    v_lshlrev_b32 v44, 16, v26
    v_and_b32 v45, 0xffff0000, v26
    v_lshlrev_b32 v46, 16, v27
    v_and_b32 v47, 0xffff0000, v27
    v_lshlrev_b32 v48, 16, v28
    v_and_b32 v49, 0xffff0000, v28
    v_lshlrev_b32 v50, 16, v29
    v_and_b32 v51, 0xffff0000, v29
    v_pk_add_f32 v[32:33], v[32:33], v[54:55] op_sel_hi:[1,0]
    v_pk_add_f32 v[34:35], v[34:35], v[54:55] op_sel_hi:[1,0]
    v_pk_add_f32 v[36:37], v[36:37], v[54:55] op_sel_hi:[1,0]
    v_pk_add_f32 v[38:39], v[38:39], v[54:55] op_sel_hi:[1,0]
    v_pk_add_f32 v[40:41], v[40:41], v[54:55] op_sel_hi:[1,0]
    v_pk_add_f32 v[42:43], v[42:43], v[54:55] op_sel_hi:[1,0]
    v_pk_add_f32 v[44:45], v[44:45], v[54:55] op_sel_hi:[1,0]
    v_pk_add_f32 v[46:47], v[46:47], v[54:55] op_sel_hi:[1,0]
    v_pk_add_f32 v[48:49], v[48:49], v[54:55] op_sel_hi:[1,0]
    v_pk_add_f32 v[50:51], v[50:51], v[54:55] op_sel_hi:[1,0]
    v_cvt_pk_bf16_f32 v8, v32, v33
    v_cvt_pk_bf16_f32 v9, v34, v35
    v_cvt_pk_bf16_f32 v10, v36, v37
    v_cvt_pk_bf16_f32 v11, v38, v39
    v_cvt_pk_bf16_f32 v12, v40, v41
    v_cvt_pk_bf16_f32 v13, v42, v43
    v_cvt_pk_bf16_f32 v14, v44, v45
    v_cvt_pk_bf16_f32 v15, v46, v47
    v_cvt_pk_bf16_f32 v16, v48, v49
    v_cvt_pk_bf16_f32 v17, v50, v51
    v_lshlrev_b32 v32, 16, v8
    v_and_b32 v33, 0xffff0000, v8
    v_lshlrev_b32 v34, 16, v9
    v_and_b32 v35, 0xffff0000, v9
    v_lshlrev_b32 v36, 16, v10
    v_and_b32 v37, 0xffff0000, v10
    v_lshlrev_b32 v38, 16, v11
    v_and_b32 v39, 0xffff0000, v11
    v_lshlrev_b32 v40, 16, v12
    v_and_b32 v41, 0xffff0000, v12
    v_lshlrev_b32 v42, 16, v13
    v_and_b32 v43, 0xffff0000, v13
    v_lshlrev_b32 v44, 16, v14
    v_and_b32 v45, 0xffff0000, v14
    v_lshlrev_b32 v46, 16, v15
    v_and_b32 v47, 0xffff0000, v15
    v_lshlrev_b32 v48, 16, v16
    v_and_b32 v49, 0xffff0000, v16
    v_lshlrev_b32 v50, 16, v17
    v_and_b32 v51, 0xffff0000, v17
    v_pk_mul_f32 v[32:33], v[32:33], v[56:57] op_sel_hi:[1,0]
    v_pk_mul_f32 v[34:35], v[34:35], v[56:57] op_sel_hi:[1,0]
    v_pk_mul_f32 v[36:37], v[36:37], v[56:57] op_sel_hi:[1,0]
    v_pk_mul_f32 v[38:39], v[38:39], v[56:57] op_sel_hi:[1,0]
    v_pk_mul_f32 v[40:41], v[40:41], v[56:57] op_sel_hi:[1,0]
    v_pk_mul_f32 v[42:43], v[42:43], v[56:57] op_sel_hi:[1,0]
    v_pk_mul_f32 v[44:45], v[44:45], v[56:57] op_sel_hi:[1,0]
    v_pk_mul_f32 v[46:47], v[46:47], v[56:57] op_sel_hi:[1,0]
    v_pk_mul_f32 v[48:49], v[48:49], v[56:57] op_sel_hi:[1,0]
    v_pk_mul_f32 v[50:51], v[50:51], v[56:57] op_sel_hi:[1,0]
    v_cvt_pk_bf16_f32 v32, v32, v32
    v_cvt_pk_bf16_f32 v33, v33, v33
    v_cvt_pk_bf16_f32 v34, v34, v34
    v_cvt_pk_bf16_f32 v35, v35, v35
    v_cvt_pk_bf16_f32 v36, v36, v36
    v_cvt_pk_bf16_f32 v37, v37, v37
    v_cvt_pk_bf16_f32 v38, v38, v38
    v_cvt_pk_bf16_f32 v39, v39, v39
    v_cvt_pk_bf16_f32 v40, v40, v40
    v_cvt_pk_bf16_f32 v41, v41, v41
    v_cvt_pk_bf16_f32 v42, v42, v42
    v_cvt_pk_bf16_f32 v43, v43, v43
    v_cvt_pk_bf16_f32 v44, v44, v44
    v_cvt_pk_bf16_f32 v45, v45, v45
    v_cvt_pk_bf16_f32 v46, v46, v46
    v_cvt_pk_bf16_f32 v47, v47, v47
    v_cvt_pk_bf16_f32 v48, v48, v48
    v_cvt_pk_bf16_f32 v49, v49, v49
    v_cvt_pk_bf16_f32 v50, v50, v50
    v_cvt_pk_bf16_f32 v51, v51, v51
    v_and_b32 v144, v32, v4
    v_and_b32 v145, v32, v5
    v_and_b32 v146, v32, v6
    v_and_b32 v148, v33, v4
    v_and_b32 v149, v33, v5
    v_and_b32 v150, v33, v6
    v_and_b32 v152, v34, v4
    v_and_b32 v153, v34, v5
    v_and_b32 v154, v34, v6
    v_and_b32 v156, v35, v4
    v_and_b32 v157, v35, v5
    v_and_b32 v158, v35, v6
    v_and_b32 v160, v36, v4
    v_and_b32 v161, v36, v5
    v_and_b32 v162, v36, v6
    v_and_b32 v164, v37, v4
    v_and_b32 v165, v37, v5
    v_and_b32 v166, v37, v6
    v_and_b32 v168, v38, v4
    v_and_b32 v169, v38, v5
    v_and_b32 v170, v38, v6
    v_and_b32 v172, v39, v4
    v_and_b32 v173, v39, v5
    v_and_b32 v174, v39, v6
    v_and_b32 v176, v40, v4
    v_and_b32 v177, v40, v5
    v_and_b32 v178, v40, v6
    v_and_b32 v180, v41, v4
    v_and_b32 v181, v41, v5
    v_and_b32 v182, v41, v6
    v_and_b32 v184, v42, v4
    v_and_b32 v185, v42, v5
    v_and_b32 v186, v42, v6
    v_and_b32 v188, v43, v4
    v_and_b32 v189, v43, v5
    v_and_b32 v190, v43, v6
    v_and_b32 v192, v44, v4
    v_and_b32 v193, v44, v5
    v_and_b32 v194, v44, v6
    v_and_b32 v196, v45, v4
    v_and_b32 v197, v45, v5
    v_and_b32 v198, v45, v6
    v_and_b32 v200, v46, v4
    v_and_b32 v201, v46, v5
    v_and_b32 v202, v46, v6
    v_and_b32 v204, v47, v4
    v_and_b32 v205, v47, v5
    v_and_b32 v206, v47, v6
    v_and_b32 v208, v48, v4
    v_and_b32 v209, v48, v5
    v_and_b32 v210, v48, v6
    v_and_b32 v212, v49, v4
    v_and_b32 v213, v49, v5
    v_and_b32 v214, v49, v6
    v_and_b32 v216, v50, v4
    v_and_b32 v217, v50, v5
    v_and_b32 v218, v50, v6
    v_and_b32 v220, v51, v4
    v_and_b32 v221, v51, v5
    v_and_b32 v222, v51, v6
    s_waitcnt vmcnt(38)
    v_mfma_f32_16x16x32_bf16 v[224:227], v[144:147], v[64:67], 0
    s_waitcnt vmcnt(36)
    v_mfma_f32_16x16x32_bf16 v[224:227], v[148:151], v[68:71], v[224:227]
    s_waitcnt vmcnt(34)
    v_mfma_f32_16x16x32_bf16 v[224:227], v[152:155], v[72:75], v[224:227]
    s_waitcnt vmcnt(32)
    v_mfma_f32_16x16x32_bf16 v[224:227], v[156:159], v[76:79], v[224:227]
    s_waitcnt vmcnt(30)
    v_mfma_f32_16x16x32_bf16 v[224:227], v[160:163], v[80:83], v[224:227]
    s_waitcnt vmcnt(28)
    v_mfma_f32_16x16x32_bf16 v[224:227], v[164:167], v[84:87], v[224:227]
    s_waitcnt vmcnt(26)
    v_mfma_f32_16x16x32_bf16 v[224:227], v[168:171], v[88:91], v[224:227]
    s_waitcnt vmcnt(24)
    v_mfma_f32_16x16x32_bf16 v[224:227], v[172:175], v[92:95], v[224:227]
    s_waitcnt vmcnt(22)
    v_mfma_f32_16x16x32_bf16 v[224:227], v[176:179], v[96:99], v[224:227]
    s_waitcnt vmcnt(20)
    v_mfma_f32_16x16x32_bf16 v[224:227], v[180:183], v[100:103], v[224:227]
    s_waitcnt vmcnt(18)
    v_mfma_f32_16x16x32_bf16 v[224:227], v[184:187], v[104:107], v[224:227]
    s_waitcnt vmcnt(16)
    v_mfma_f32_16x16x32_bf16 v[224:227], v[188:191], v[108:111], v[224:227]
    s_waitcnt vmcnt(14)
    v_mfma_f32_16x16x32_bf16 v[224:227], v[192:195], v[112:115], v[224:227]
    s_waitcnt vmcnt(12)
    v_mfma_f32_16x16x32_bf16 v[224:227], v[196:199], v[116:119], v[224:227]
    s_waitcnt vmcnt(10)
    v_mfma_f32_16x16x32_bf16 v[224:227], v[200:203], v[120:123], v[224:227]
    s_waitcnt vmcnt(8)
    v_mfma_f32_16x16x32_bf16 v[224:227], v[204:207], v[124:127], v[224:227]
    s_waitcnt vmcnt(6)
    v_mfma_f32_16x16x32_bf16 v[224:227], v[208:211], v[128:131], v[224:227]
    s_waitcnt vmcnt(4)
    v_mfma_f32_16x16x32_bf16 v[224:227], v[212:215], v[132:135], v[224:227]
    s_waitcnt vmcnt(2)
    v_mfma_f32_16x16x32_bf16 v[224:227], v[216:219], v[136:139], v[224:227]
    s_waitcnt vmcnt(0)
    v_mfma_f32_16x16x32_bf16 v[224:227], v[220:223], v[140:143], v[224:227]
    s_waitcnt lgkmcnt(0)
    s_mul_i32 s7, s6, 0x9E3779B1
    s_add_u32 s7, s7, 0x7F4A7C15
    s_add_u32 s53, s6, 0x55
    s_and_b32 s53, s53, 0x7F
    s_or_b32 s53, s53, 0x80
    v_lshlrev_b32 v8, 4, v0
    s_lshl_b32 s44, s2, 10
    s_add_u32 s44, s44, 589824
    v_mov_b32 v227, s7
    buffer_store_dwordx4 v[224:227], v8, s[40:43], s44 offen sc1
    s_barrier
    s_branch L_Spost
L_S3:
    s_waitcnt lgkmcnt(0)
    s_load_dword s6, s[30:31], 0
    s_mov_b32 s40, s30
    s_mov_b32 s41, s31
    s_mov_b32 s42, 4194304
    s_mov_b32 s43, 0x00020000
    s_barrier
    s_waitcnt lgkmcnt(0)
    s_mul_i32 s7, s6, 0x9E3779B1
    s_add_u32 s7, s7, 0x7F4A7C15
    s_add_u32 s53, s6, 0x55
    s_and_b32 s53, s53, 0x7F
    s_or_b32 s53, s53, 0x80
    s_getreg_b32 s62, hwreg(HW_REG_XCC_ID)
    s_and_b32 s62, s62, 15
    s_and_b32 s58, s7, 0xfffffff0
    s_or_b32 s62, s62, s58
    s_lshl_b32 s44, s63, 4
    s_add_u32 s44, s44, 1310720
    v_mov_b32 v8, s62
    v_mov_b32 v9, 0
    s_mov_b64 exec, 1
    buffer_store_dword v8, v9, s[40:43], s44 offen sc1
    s_mov_b64 exec, -1
    s_cmp_lt_u32 s2, 80
    s_cbranch_scc0 L_nopw
    s_xor_b32 s45, s2, 1
    s_bfe_u32 s46, s45, 0x30001
    s_and_b32 s47, s45, 1
    s_lshl_b32 s47, s47, 17
    s_lshr_b32 s45, s45, 4
    s_lshl_b32 s45, s45, 7
    s_add_u32 s47, s47, s45
    s_add_u32 s44, s47, 1575424
    v_and_b32 v11, 3, v0
    v_lshlrev_b32 v11, 15, v11
    v_bfe_u32 v12, v0, 2, 1
    v_lshlrev_b32 v13, 1, v12
    v_xor_b32 v13, s46, v13
    v_lshl_add_u32 v11, v13, 12, v11
    v_lshl_add_u32 v11, v12, 18, v11
    s_mov_b64 exec, 0xff
    buffer_store_dword v12, v11, s[40:43], s44 offen sc1
    s_mov_b64 exec, -1
L_nopw:
    s_barrier
L_Spost:
    s_mul_i32 s57, s54, 245760
    s_mul_i32 s58, s3, 61440
    s_add_u32 s57, s57, s58
    s_mul_i32 s58, s52, 160
    s_add_u32 s57, s57, s58
    s_add_u32 s32, s16, s57
    s_addc_u32 s33, s17, 0
    s_mov_b32 s34, 61440
    s_mov_b32 s35, 0x00020000
    v_mul_u32_u24 v28, 15360, v2
    v_lshl_add_u32 v28, v3, 4, v28
    s_mov_b32 exec_lo, 0x03ff03ff
    s_mov_b32 exec_hi, 0x03ff03ff
    s_mov_b32 s44, 0
    buffer_load_dwordx4 v[64:67], v28, s[32:35], s44 offen offset:0 nt
    buffer_load_dwordx4 v[68:71], v28, s[32:35], s44 offen offset:1280 nt
    buffer_load_dwordx4 v[72:75], v28, s[32:35], s44 offen offset:2560 nt
    buffer_load_dwordx4 v[76:79], v28, s[32:35], s44 offen offset:3840 nt
    s_mov_b32 s44, 5120
    buffer_load_dwordx4 v[80:83], v28, s[32:35], s44 offen offset:0 nt
    buffer_load_dwordx4 v[84:87], v28, s[32:35], s44 offen offset:1280 nt
    buffer_load_dwordx4 v[88:91], v28, s[32:35], s44 offen offset:2560 nt
    buffer_load_dwordx4 v[92:95], v28, s[32:35], s44 offen offset:3840 nt
    s_mov_b32 s44, 10240
    buffer_load_dwordx4 v[96:99], v28, s[32:35], s44 offen offset:0 nt
    buffer_load_dwordx4 v[100:103], v28, s[32:35], s44 offen offset:1280 nt
    buffer_load_dwordx4 v[104:107], v28, s[32:35], s44 offen offset:2560 nt
    buffer_load_dwordx4 v[108:111], v28, s[32:35], s44 offen offset:3840 nt
    s_mov_b64 exec, -1
    v_mov_b32 v180, 0
    v_mov_b32 v181, 0
    v_mov_b32 v182, 0
    v_mov_b32 v183, 0
    v_mov_b32 v184, 0
    v_mov_b32 v185, 0
    v_mov_b32 v186, 0
    v_mov_b32 v187, 0
    v_mov_b32 v188, 0
    v_mov_b32 v189, 0
    s_min_u32 s57, s2, 79
    s_bfe_u32 s58, s57, 0x30001
    s_mul_i32 s58, s58, 160
    s_and_b32 s59, s57, 1
    s_mul_i32 s59, s59, 1280
    s_add_u32 s58, s58, s59
    s_lshr_b32 s59, s57, 4
    s_lshl_b32 s59, s59, 5
    s_add_u32 s60, s58, s59
    v_and_b32 v62, 1, v2
    v_lshlrev_b32 v62, 1, v62
    v_lshrrev_b32 v61, 1, v2
    v_or_b32 v62, v62, v61
    v_and_b32 v61, 3, v3
    v_lshl_add_u32 v62, v61, 2, v62
    v_lshlrev_b32 v62, 1, v62
    s_mov_b32 s36, s8
    s_mov_b32 s37, s9
    s_mov_b32 s38, 2560
    s_mov_b32 s39, 0x00020000
    buffer_load_ushort v63, v62, s[36:39], s60 offen
    s_cmp_eq_u32 s3, 3
    s_cbranch_scc0 L_wo2
    s_mul_i32 s57, s54, 61440
    s_mul_i32 s58, s52, 160
    s_add_u32 s57, s57, s58
    s_add_u32 s36, s24, s57
    s_addc_u32 s37, s25, 0
    s_mov_b32 s38, 61440
    s_mov_b32 s39, 0x00020000
    s_mov_b32 exec_lo, 0x03ff03ff
    s_mov_b32 exec_hi, 0x03ff03ff
    s_mov_b32 s44, 0
    buffer_load_dwordx4 v[112:115], v28, s[36:39], s44 offen offset:0 nt
    buffer_load_dwordx4 v[116:119], v28, s[36:39], s44 offen offset:1280 nt
    buffer_load_dwordx4 v[120:123], v28, s[36:39], s44 offen offset:2560 nt
    buffer_load_dwordx4 v[124:127], v28, s[36:39], s44 offen offset:3840 nt
    s_mov_b32 s44, 5120
    buffer_load_dwordx4 v[128:131], v28, s[36:39], s44 offen offset:0 nt
    buffer_load_dwordx4 v[132:135], v28, s[36:39], s44 offen offset:1280 nt
    buffer_load_dwordx4 v[136:139], v28, s[36:39], s44 offen offset:2560 nt
    buffer_load_dwordx4 v[140:143], v28, s[36:39], s44 offen offset:3840 nt
    s_mov_b32 s44, 10240
    buffer_load_dwordx4 v[144:147], v28, s[36:39], s44 offen offset:0 nt
    buffer_load_dwordx4 v[148:151], v28, s[36:39], s44 offen offset:1280 nt
    buffer_load_dwordx4 v[152:155], v28, s[36:39], s44 offen offset:2560 nt
    buffer_load_dwordx4 v[156:159], v28, s[36:39], s44 offen offset:3840 nt
    s_mov_b64 exec, -1
    v_lshlrev_b32 v29, 4, v0
    s_lshl_b32 s44, s54, 13
    s_add_u32 s44, s44, 589824
    s_add_u32 s45, s44, 4096
    s_mov_b32 s55, 200000
L_gpoll_3:
    buffer_load_dwordx4 v[160:163], v29, s[40:43], s44 offen offset:0 sc1
    buffer_load_dwordx4 v[164:167], v29, s[40:43], s44 offen offset:1024 sc1
    buffer_load_dwordx4 v[168:171], v29, s[40:43], s44 offen offset:2048 sc1
    buffer_load_dwordx4 v[172:175], v29, s[40:43], s44 offen offset:3072 sc1
    buffer_load_dwordx4 v[176:179], v29, s[40:43], s45 offen offset:0 sc1
    buffer_load_dwordx4 v[180:183], v29, s[40:43], s45 offen offset:1024 sc1
    buffer_load_dwordx4 v[184:187], v29, s[40:43], s45 offen offset:2048 sc1
    buffer_load_dwordx4 v[188:191], v29, s[40:43], s45 offen offset:3072 sc1
    s_waitcnt vmcnt(0)
    v_xor_b32 v8, s7, v163
    v_xor_b32 v9, s7, v167
    v_xor_b32 v10, s7, v171
    v_xor_b32 v11, s7, v175
    v_xor_b32 v12, s7, v179
    v_xor_b32 v13, s7, v183
    v_xor_b32 v14, s7, v187
    v_xor_b32 v15, s7, v191
    v_or3_b32 v8, v8, v9, v10
    v_or3_b32 v11, v11, v12, v13
    v_or3_b32 v8, v8, v14, v15
    v_or_b32 v8, v8, v11
    v_cmp_ne_u32 vcc, 0, v8
    s_cbranch_vccz L_done_4
    s_sub_u32 s55, s55, 1
    s_cbranch_scc0 L_gpoll_3
L_done_4:
    v_pk_add_f32 v[160:161], v[160:161], v[164:165]
    v_add_f32 v162, v162, v166
    v_pk_add_f32 v[168:169], v[168:169], v[172:173]
    v_add_f32 v170, v170, v174
    v_pk_add_f32 v[176:177], v[176:177], v[180:181]
    v_add_f32 v178, v178, v182
    v_pk_add_f32 v[184:185], v[184:185], v[188:189]
    v_add_f32 v186, v186, v190
    v_pk_add_f32 v[160:161], v[160:161], v[168:169]
    v_add_f32 v162, v162, v170
    v_pk_add_f32 v[176:177], v[176:177], v[184:185]
    v_add_f32 v178, v178, v186
    v_pk_add_f32 v[160:161], v[160:161], v[176:177]
    v_add_f32 v162, v162, v178
    v_cvt_pk_bf16_f32 v160, v160, v160
    v_and_b32 v160, 0xffff0000, v160
    v_cvt_pk_bf16_f32 v161, v161, v161
    v_and_b32 v161, 0xffff0000, v161
    v_cvt_pk_bf16_f32 v162, v162, v162
    v_and_b32 v162, 0xffff0000, v162
    v_mov_b32_dpp v164, v160 row_ror:8 row_mask:0xf bank_mask:0xf
    v_mov_b32_dpp v165, v161 row_ror:8 row_mask:0xf bank_mask:0xf
    v_mov_b32_dpp v166, v162 row_ror:8 row_mask:0xf bank_mask:0xf
    v_mul_f32 v168, v160, v160
    v_mul_f32 v168, 0x3d372713, v168
    v_fma_f32 v168, v168, v160, v160
    v_mul_f32 v168, 0xc0135761, v168
    v_exp_f32 v168, v168
    s_nop 0
    v_add_f32 v168, 1.0, v168
    v_rcp_f32 v168, v168
    s_nop 0
    v_mul_f32 v168, v168, v160
    v_cvt_pk_bf16_f32 v168, v168, v168
    v_and_b32 v168, 0xffff0000, v168
    v_mul_f32 v168, v168, v164
    v_cvt_pk_bf16_f32 v168, v168, v168
    v_mul_f32 v169, v161, v161
    v_mul_f32 v169, 0x3d372713, v169
    v_fma_f32 v169, v169, v161, v161
    v_mul_f32 v169, 0xc0135761, v169
    v_exp_f32 v169, v169
    s_nop 0
    v_add_f32 v169, 1.0, v169
    v_rcp_f32 v169, v169
    s_nop 0
    v_mul_f32 v169, v169, v161
    v_cvt_pk_bf16_f32 v169, v169, v169
    v_and_b32 v169, 0xffff0000, v169
    v_mul_f32 v169, v169, v165
    v_cvt_pk_bf16_f32 v169, v169, v169
    v_mul_f32 v170, v162, v162
    v_mul_f32 v170, 0x3d372713, v170
    v_fma_f32 v170, v170, v162, v162
    v_mul_f32 v170, 0xc0135761, v170
    v_exp_f32 v170, v170
    s_nop 0
    v_add_f32 v170, 1.0, v170
    v_rcp_f32 v170, v170
    s_nop 0
    v_mul_f32 v170, v170, v162
    v_cvt_pk_bf16_f32 v170, v170, v170
    v_and_b32 v170, 0xffff0000, v170
    v_mul_f32 v170, v170, v166
    v_cvt_pk_bf16_f32 v170, v170, v170
    v_lshrrev_b32 v8, 1, v2
    v_mul_u32_u24 v8, 48, v8
    v_and_b32 v9, 1, v2
    v_mul_u32_u24 v9, 3, v9
    v_mul_u32_u24 v10, 6, v3
    v_add3_u32 v8, v8, v9, v10
    v_lshlrev_b32 v8, 2, v8
    s_mov_b32 exec_lo, 0x00ff00ff
    s_mov_b32 exec_hi, 0x00ff00ff
    ds_write_b32 v8, v168 offset:512
    ds_write_b32 v8, v169 offset:516
    ds_write_b32 v8, v170 offset:520
    s_mov_b64 exec, -1
    v_bfe_u32 v9, v3, 2, 1
    v_mul_u32_u24 v9, 192, v9
    v_lshl_add_u32 v9, v2, 4, v9
    s_waitcnt lgkmcnt(0)
    ds_read_b128 v[20:23], v9 offset:512
    ds_read_b128 v[12:15], v9 offset:576
    ds_read_b128 v[16:19], v9 offset:640
    s_mov_b32 s45, 0xffff
    s_waitcnt lgkmcnt(0)
    v_bfi_b32 v8, s45, v20, v21
    v_bfi_b32 v9, s45, v22, v23
    v_bfi_b32 v10, s45, v12, v13
    v_bfi_b32 v11, s45, v14, v15
    v_bfi_b32 v12, s45, v16, v17
    v_bfi_b32 v13, s45, v18, v19
    v_mov_b32 v180, 0
    v_mov_b32 v181, 0
    v_mov_b32 v182, 0
    v_mov_b32 v183, 0
    v_mov_b32 v184, 0
    v_mov_b32 v185, 0
    v_mov_b32 v186, 0
    v_mov_b32 v187, 0
    v_mov_b32 v188, 0
    v_mov_b32 v189, 0
    s_mul_i32 s45, s3, 2560
    s_add_u32 s45, s45, 1280
    v_mul_u32_u24 v32, 1920, v2
    v_lshl_add_u32 v32, v3, 4, v32
    v_add_u32 v32, s45, v32
    v_mul_u32_u24 v34, 640, v2
    v_lshl_add_u32 v34, v3, 1, v34
    v_add_u32 v34, s45, v34
    s_mov_b32 exec_lo, 0x3ff03ff
    s_mov_b32 exec_hi, 0x0
    ds_write_b128 v32, v[112:115] offset:0
    s_mov_b32 exec_lo, 0x3ff03ff
    s_mov_b32 exec_hi, 0x0
    ds_write_b128 v32, v[116:119] offset:160
    s_mov_b32 exec_lo, 0x3ff03ff
    s_mov_b32 exec_hi, 0x0
    ds_write_b128 v32, v[120:123] offset:320
    s_mov_b32 exec_lo, 0x3ff03ff
    s_mov_b32 exec_hi, 0x0
    ds_write_b128 v32, v[124:127] offset:480
    s_mov_b32 exec_lo, 0x3ff
    s_mov_b32 exec_hi, 0x0
    ds_write_b128 v32, v[128:131] offset:640
    s_mov_b32 exec_lo, 0x3ff
    s_mov_b32 exec_hi, 0x0
    ds_write_b128 v32, v[132:135] offset:800
    s_mov_b32 exec_lo, 0x3ff
    s_mov_b32 exec_hi, 0x0
    ds_write_b128 v32, v[136:139] offset:960
    s_mov_b32 exec_lo, 0x3ff
    s_mov_b32 exec_hi, 0x0
    ds_write_b128 v32, v[140:143] offset:1120
    s_mov_b32 exec_lo, 0x3ff
    s_mov_b32 exec_hi, 0x0
    ds_write_b128 v32, v[144:147] offset:1280
    s_mov_b32 exec_lo, 0x3ff
    s_mov_b32 exec_hi, 0x0
    ds_write_b128 v32, v[148:151] offset:1440
    s_mov_b32 exec_lo, 0x3ff
    s_mov_b32 exec_hi, 0x0
    ds_write_b128 v32, v[152:155] offset:1600
    s_mov_b32 exec_lo, 0x3ff
    s_mov_b32 exec_hi, 0x0
    ds_write_b128 v32, v[156:159] offset:1760
    s_mov_b64 exec, -1
    s_waitcnt lgkmcnt(0)
    ds_read_u16 v216, v34 offset:0
    ds_read_u16 v20, v34 offset:160
    ds_read_u16 v217, v34 offset:320
    ds_read_u16 v21, v34 offset:480
    ds_read_u16 v220, v34 offset:32
    ds_read_u16 v22, v34 offset:192
    ds_read_u16 v221, v34 offset:352
    ds_read_u16 v23, v34 offset:512
    ds_read_u16 v224, v34 offset:64
    ds_read_u16 v24, v34 offset:224
    ds_read_u16 v225, v34 offset:384
    ds_read_u16 v25, v34 offset:544
    s_waitcnt lgkmcnt(0)
    v_lshl_or_b32 v216, v20, 16, v216
    v_lshl_or_b32 v217, v21, 16, v217
    v_lshl_or_b32 v220, v22, 16, v220
    v_lshl_or_b32 v221, v23, 16, v221
    v_lshl_or_b32 v224, v24, 16, v224
    v_lshl_or_b32 v225, v25, 16, v225
    ds_read_u16 v228, v34 offset:96
    ds_read_u16 v20, v34 offset:256
    ds_read_u16 v229, v34 offset:416
    ds_read_u16 v21, v34 offset:576
    ds_read_u16 v232, v34 offset:128
    ds_read_u16 v22, v34 offset:288
    ds_read_u16 v233, v34 offset:448
    ds_read_u16 v23, v34 offset:608
    s_waitcnt lgkmcnt(0)
    v_lshl_or_b32 v228, v20, 16, v228
    v_lshl_or_b32 v229, v21, 16, v229
    v_lshl_or_b32 v232, v22, 16, v232
    v_lshl_or_b32 v233, v23, 16, v233
    v_subrev_u32 v32, 2560, v32
    s_mov_b32 exec_lo, 0x0
    s_mov_b32 exec_hi, 0x3ff
    ds_write_b128 v32, v[112:115] offset:0
    s_mov_b32 exec_lo, 0x0
    s_mov_b32 exec_hi, 0x3ff
    ds_write_b128 v32, v[116:119] offset:160
    s_mov_b32 exec_lo, 0x0
    s_mov_b32 exec_hi, 0x3ff
    ds_write_b128 v32, v[120:123] offset:320
    s_mov_b32 exec_lo, 0x0
    s_mov_b32 exec_hi, 0x3ff
    ds_write_b128 v32, v[124:127] offset:480
    s_mov_b32 exec_lo, 0x3ff0000
    s_mov_b32 exec_hi, 0x3ff
    ds_write_b128 v32, v[128:131] offset:640
    s_mov_b32 exec_lo, 0x3ff0000
    s_mov_b32 exec_hi, 0x3ff
    ds_write_b128 v32, v[132:135] offset:800
    s_mov_b32 exec_lo, 0x3ff0000
    s_mov_b32 exec_hi, 0x3ff
    ds_write_b128 v32, v[136:139] offset:960
    s_mov_b32 exec_lo, 0x3ff0000
    s_mov_b32 exec_hi, 0x3ff
    ds_write_b128 v32, v[140:143] offset:1120
    s_mov_b32 exec_lo, 0x3ff0000
    s_mov_b32 exec_hi, 0x0
    ds_write_b128 v32, v[144:147] offset:1280
    s_mov_b32 exec_lo, 0x3ff0000
    s_mov_b32 exec_hi, 0x0
    ds_write_b128 v32, v[148:151] offset:1440
    s_mov_b32 exec_lo, 0x3ff0000
    s_mov_b32 exec_hi, 0x0
    ds_write_b128 v32, v[152:155] offset:1600
    s_mov_b32 exec_lo, 0x3ff0000
    s_mov_b32 exec_hi, 0x0
    ds_write_b128 v32, v[156:159] offset:1760
    s_mov_b64 exec, -1
    s_waitcnt lgkmcnt(0)
    ds_read_u16 v218, v34 offset:0
    ds_read_u16 v20, v34 offset:160
    ds_read_u16 v219, v34 offset:320
    ds_read_u16 v21, v34 offset:480
    ds_read_u16 v222, v34 offset:32
    ds_read_u16 v22, v34 offset:192
    ds_read_u16 v223, v34 offset:352
    ds_read_u16 v23, v34 offset:512
    ds_read_u16 v226, v34 offset:64
    ds_read_u16 v24, v34 offset:224
    ds_read_u16 v227, v34 offset:384
    ds_read_u16 v25, v34 offset:544
    s_waitcnt lgkmcnt(0)
    v_lshl_or_b32 v218, v20, 16, v218
    v_lshl_or_b32 v219, v21, 16, v219
    v_lshl_or_b32 v222, v22, 16, v222
    v_lshl_or_b32 v223, v23, 16, v223
    v_lshl_or_b32 v226, v24, 16, v226
    v_lshl_or_b32 v227, v25, 16, v227
    ds_read_u16 v230, v34 offset:96
    ds_read_u16 v20, v34 offset:256
    ds_read_u16 v231, v34 offset:416
    ds_read_u16 v21, v34 offset:576
    ds_read_u16 v234, v34 offset:128
    ds_read_u16 v22, v34 offset:288
    ds_read_u16 v235, v34 offset:448
    ds_read_u16 v23, v34 offset:608
    s_waitcnt lgkmcnt(0)
    v_lshl_or_b32 v230, v20, 16, v230
    v_lshl_or_b32 v231, v21, 16, v231
    v_lshl_or_b32 v234, v22, 16, v234
    v_lshl_or_b32 v235, v23, 16, v235
    v_subrev_u32 v32, 2560, v32
    s_mov_b32 exec_lo, 0x0
    s_mov_b32 exec_hi, 0x3ff0000
    ds_write_b128 v32, v[112:115] offset:0
    s_mov_b32 exec_lo, 0x0
    s_mov_b32 exec_hi, 0x3ff0000
    ds_write_b128 v32, v[116:119] offset:160
    s_mov_b32 exec_lo, 0x0
    s_mov_b32 exec_hi, 0x3ff0000
    ds_write_b128 v32, v[120:123] offset:320
    s_mov_b32 exec_lo, 0x0
    s_mov_b32 exec_hi, 0x3ff0000
    ds_write_b128 v32, v[124:127] offset:480
    s_mov_b32 exec_lo, 0x0
    s_mov_b32 exec_hi, 0x3ff0000
    ds_write_b128 v32, v[128:131] offset:640
    s_mov_b32 exec_lo, 0x0
    s_mov_b32 exec_hi, 0x3ff0000
    ds_write_b128 v32, v[132:135] offset:800
    s_mov_b32 exec_lo, 0x0
    s_mov_b32 exec_hi, 0x3ff0000
    ds_write_b128 v32, v[136:139] offset:960
    s_mov_b32 exec_lo, 0x0
    s_mov_b32 exec_hi, 0x3ff0000
    ds_write_b128 v32, v[140:143] offset:1120
    s_mov_b32 exec_lo, 0x0
    s_mov_b32 exec_hi, 0x3ff03ff
    ds_write_b128 v32, v[144:147] offset:1280
    s_mov_b32 exec_lo, 0x0
    s_mov_b32 exec_hi, 0x3ff03ff
    ds_write_b128 v32, v[148:151] offset:1440
    s_mov_b32 exec_lo, 0x0
    s_mov_b32 exec_hi, 0x3ff03ff
    ds_write_b128 v32, v[152:155] offset:1600
    s_mov_b32 exec_lo, 0x0
    s_mov_b32 exec_hi, 0x3ff03ff
    ds_write_b128 v32, v[156:159] offset:1760
    s_mov_b64 exec, -1
    s_waitcnt lgkmcnt(0)
    ds_read_u16 v236, v34 offset:0
    ds_read_u16 v20, v34 offset:160
    ds_read_u16 v237, v34 offset:320
    ds_read_u16 v21, v34 offset:480
    ds_read_u16 v238, v34 offset:32
    ds_read_u16 v22, v34 offset:192
    ds_read_u16 v239, v34 offset:352
    ds_read_u16 v23, v34 offset:512
    ds_read_u16 v240, v34 offset:64
    ds_read_u16 v24, v34 offset:224
    ds_read_u16 v241, v34 offset:384
    ds_read_u16 v25, v34 offset:544
    s_waitcnt lgkmcnt(0)
    v_lshl_or_b32 v236, v20, 16, v236
    v_lshl_or_b32 v237, v21, 16, v237
    v_lshl_or_b32 v238, v22, 16, v238
    v_lshl_or_b32 v239, v23, 16, v239
    v_lshl_or_b32 v240, v24, 16, v240
    v_lshl_or_b32 v241, v25, 16, v241
    ds_read_u16 v242, v34 offset:96
    ds_read_u16 v20, v34 offset:256
    ds_read_u16 v243, v34 offset:416
    ds_read_u16 v21, v34 offset:576
    ds_read_u16 v244, v34 offset:128
    ds_read_u16 v22, v34 offset:288
    ds_read_u16 v245, v34 offset:448
    ds_read_u16 v23, v34 offset:608
    s_waitcnt lgkmcnt(0)
    v_lshl_or_b32 v242, v20, 16, v242
    v_lshl_or_b32 v243, v21, 16, v243
    v_lshl_or_b32 v244, v22, 16, v244
    v_lshl_or_b32 v245, v23, 16, v245
    v_mfma_f32_16x16x32_bf16 v[160:163], v[8:11], v[216:219], 0
    v_mfma_f32_16x16x32_bf16 v[164:167], v[8:11], v[220:223], 0
    v_mfma_f32_16x16x32_bf16 v[168:171], v[8:11], v[224:227], 0
    v_mfma_f32_16x16x32_bf16 v[172:175], v[8:11], v[228:231], 0
    v_mfma_f32_16x16x32_bf16 v[176:179], v[8:11], v[232:235], 0
    s_nop 7
    v_mfma_f32_16x16x16_bf16 v[160:163], v[12:13], v[236:237], v[160:163]
    v_mfma_f32_16x16x16_bf16 v[164:167], v[12:13], v[238:239], v[164:167]
    v_mfma_f32_16x16x16_bf16 v[168:171], v[12:13], v[240:241], v[168:171]
    v_mfma_f32_16x16x16_bf16 v[172:175], v[12:13], v[242:243], v[172:175]
    v_mfma_f32_16x16x16_bf16 v[176:179], v[12:13], v[244:245], v[176:179]
    s_nop 3
    v_mov_b32 v180, v160
    v_mov_b32 v182, v164
    v_mov_b32 v184, v168
    v_mov_b32 v186, v172
    v_mov_b32 v188, v176
    v_and_b32 v8, 7, v0
    v_lshlrev_b32 v8, 4, v8
    s_lshl_b32 s44, s54, 7
    s_add_u32 s44, s44, 1310720
    s_mov_b32 s55, 200000
L_xpoll_5:
    buffer_load_dword v9, v8, s[40:43], s44 offen sc1
    s_waitcnt vmcnt(0)
    v_xor_b32 v9, s62, v9
    v_and_b32 v10, 0xfffffff0, v9
    v_cmp_ne_u32 vcc, 0, v10
    s_cbranch_vccz L_done_6
    s_sub_u32 s55, s55, 1
    s_cbranch_scc0 L_xpoll_5
L_done_6:
    v_cmp_ne_u32 vcc, 0, v9
    s_cmp_eq_u64 vcc, 0
    s_cselect_b32 s58, 1, 0
    v_mov_b32 v10, s58
    v_mov_b32 v11, 0
    ds_write_b32 v11, v10 offset:912
    s_waitcnt lgkmcnt(0)
L_wo2:
    s_waitcnt vmcnt(0)
    s_mul_i32 s45, s3, 2560
    s_add_u32 s45, s45, 1280
    v_mul_u32_u24 v32, 1920, v2
    v_lshl_add_u32 v32, v3, 4, v32
    v_add_u32 v32, s45, v32
    v_mul_u32_u24 v34, 640, v2
    v_lshl_add_u32 v34, v3, 1, v34
    v_add_u32 v34, s45, v34
    s_mov_b32 exec_lo, 0x3ff03ff
    s_mov_b32 exec_hi, 0x0
    ds_write_b128 v32, v[64:67] offset:0
    s_mov_b32 exec_lo, 0x3ff03ff
    s_mov_b32 exec_hi, 0x0
    ds_write_b128 v32, v[68:71] offset:160
    s_mov_b32 exec_lo, 0x3ff03ff
    s_mov_b32 exec_hi, 0x0
    ds_write_b128 v32, v[72:75] offset:320
    s_mov_b32 exec_lo, 0x3ff03ff
    s_mov_b32 exec_hi, 0x0
    ds_write_b128 v32, v[76:79] offset:480
    s_mov_b32 exec_lo, 0x3ff
    s_mov_b32 exec_hi, 0x0
    ds_write_b128 v32, v[80:83] offset:640
    s_mov_b32 exec_lo, 0x3ff
    s_mov_b32 exec_hi, 0x0
    ds_write_b128 v32, v[84:87] offset:800
    s_mov_b32 exec_lo, 0x3ff
    s_mov_b32 exec_hi, 0x0
    ds_write_b128 v32, v[88:91] offset:960
    s_mov_b32 exec_lo, 0x3ff
    s_mov_b32 exec_hi, 0x0
    ds_write_b128 v32, v[92:95] offset:1120
    s_mov_b32 exec_lo, 0x3ff
    s_mov_b32 exec_hi, 0x0
    ds_write_b128 v32, v[96:99] offset:1280
    s_mov_b32 exec_lo, 0x3ff
    s_mov_b32 exec_hi, 0x0
    ds_write_b128 v32, v[100:103] offset:1440
    s_mov_b32 exec_lo, 0x3ff
    s_mov_b32 exec_hi, 0x0
    ds_write_b128 v32, v[104:107] offset:1600
    s_mov_b32 exec_lo, 0x3ff
    s_mov_b32 exec_hi, 0x0
    ds_write_b128 v32, v[108:111] offset:1760
    s_mov_b64 exec, -1
    s_waitcnt lgkmcnt(0)
    ds_read_u16 v216, v34 offset:0
    ds_read_u16 v20, v34 offset:160
    ds_read_u16 v217, v34 offset:320
    ds_read_u16 v21, v34 offset:480
    ds_read_u16 v220, v34 offset:32
    ds_read_u16 v22, v34 offset:192
    ds_read_u16 v221, v34 offset:352
    ds_read_u16 v23, v34 offset:512
    ds_read_u16 v224, v34 offset:64
    ds_read_u16 v24, v34 offset:224
    ds_read_u16 v225, v34 offset:384
    ds_read_u16 v25, v34 offset:544
    s_waitcnt lgkmcnt(0)
    v_lshl_or_b32 v216, v20, 16, v216
    v_lshl_or_b32 v217, v21, 16, v217
    v_lshl_or_b32 v220, v22, 16, v220
    v_lshl_or_b32 v221, v23, 16, v221
    v_lshl_or_b32 v224, v24, 16, v224
    v_lshl_or_b32 v225, v25, 16, v225
    ds_read_u16 v228, v34 offset:96
    ds_read_u16 v20, v34 offset:256
    ds_read_u16 v229, v34 offset:416
    ds_read_u16 v21, v34 offset:576
    ds_read_u16 v232, v34 offset:128
    ds_read_u16 v22, v34 offset:288
    ds_read_u16 v233, v34 offset:448
    ds_read_u16 v23, v34 offset:608
    s_waitcnt lgkmcnt(0)
    v_lshl_or_b32 v228, v20, 16, v228
    v_lshl_or_b32 v229, v21, 16, v229
    v_lshl_or_b32 v232, v22, 16, v232
    v_lshl_or_b32 v233, v23, 16, v233
    v_subrev_u32 v32, 2560, v32
    s_mov_b32 exec_lo, 0x0
    s_mov_b32 exec_hi, 0x3ff
    ds_write_b128 v32, v[64:67] offset:0
    s_mov_b32 exec_lo, 0x0
    s_mov_b32 exec_hi, 0x3ff
    ds_write_b128 v32, v[68:71] offset:160
    s_mov_b32 exec_lo, 0x0
    s_mov_b32 exec_hi, 0x3ff
    ds_write_b128 v32, v[72:75] offset:320
    s_mov_b32 exec_lo, 0x0
    s_mov_b32 exec_hi, 0x3ff
    ds_write_b128 v32, v[76:79] offset:480
    s_mov_b32 exec_lo, 0x3ff0000
    s_mov_b32 exec_hi, 0x3ff
    ds_write_b128 v32, v[80:83] offset:640
    s_mov_b32 exec_lo, 0x3ff0000
    s_mov_b32 exec_hi, 0x3ff
    ds_write_b128 v32, v[84:87] offset:800
    s_mov_b32 exec_lo, 0x3ff0000
    s_mov_b32 exec_hi, 0x3ff
    ds_write_b128 v32, v[88:91] offset:960
    s_mov_b32 exec_lo, 0x3ff0000
    s_mov_b32 exec_hi, 0x3ff
    ds_write_b128 v32, v[92:95] offset:1120
    s_mov_b32 exec_lo, 0x3ff0000
    s_mov_b32 exec_hi, 0x0
    ds_write_b128 v32, v[96:99] offset:1280
    s_mov_b32 exec_lo, 0x3ff0000
    s_mov_b32 exec_hi, 0x0
    ds_write_b128 v32, v[100:103] offset:1440
    s_mov_b32 exec_lo, 0x3ff0000
    s_mov_b32 exec_hi, 0x0
    ds_write_b128 v32, v[104:107] offset:1600
    s_mov_b32 exec_lo, 0x3ff0000
    s_mov_b32 exec_hi, 0x0
    ds_write_b128 v32, v[108:111] offset:1760
    s_mov_b64 exec, -1
    s_waitcnt lgkmcnt(0)
    ds_read_u16 v218, v34 offset:0
    ds_read_u16 v20, v34 offset:160
    ds_read_u16 v219, v34 offset:320
    ds_read_u16 v21, v34 offset:480
    ds_read_u16 v222, v34 offset:32
    ds_read_u16 v22, v34 offset:192
    ds_read_u16 v223, v34 offset:352
    ds_read_u16 v23, v34 offset:512
    ds_read_u16 v226, v34 offset:64
    ds_read_u16 v24, v34 offset:224
    ds_read_u16 v227, v34 offset:384
    ds_read_u16 v25, v34 offset:544
    s_waitcnt lgkmcnt(0)
    v_lshl_or_b32 v218, v20, 16, v218
    v_lshl_or_b32 v219, v21, 16, v219
    v_lshl_or_b32 v222, v22, 16, v222
    v_lshl_or_b32 v223, v23, 16, v223
    v_lshl_or_b32 v226, v24, 16, v226
    v_lshl_or_b32 v227, v25, 16, v227
    ds_read_u16 v230, v34 offset:96
    ds_read_u16 v20, v34 offset:256
    ds_read_u16 v231, v34 offset:416
    ds_read_u16 v21, v34 offset:576
    ds_read_u16 v234, v34 offset:128
    ds_read_u16 v22, v34 offset:288
    ds_read_u16 v235, v34 offset:448
    ds_read_u16 v23, v34 offset:608
    s_waitcnt lgkmcnt(0)
    v_lshl_or_b32 v230, v20, 16, v230
    v_lshl_or_b32 v231, v21, 16, v231
    v_lshl_or_b32 v234, v22, 16, v234
    v_lshl_or_b32 v235, v23, 16, v235
    v_subrev_u32 v32, 2560, v32
    s_mov_b32 exec_lo, 0x0
    s_mov_b32 exec_hi, 0x3ff0000
    ds_write_b128 v32, v[64:67] offset:0
    s_mov_b32 exec_lo, 0x0
    s_mov_b32 exec_hi, 0x3ff0000
    ds_write_b128 v32, v[68:71] offset:160
    s_mov_b32 exec_lo, 0x0
    s_mov_b32 exec_hi, 0x3ff0000
    ds_write_b128 v32, v[72:75] offset:320
    s_mov_b32 exec_lo, 0x0
    s_mov_b32 exec_hi, 0x3ff0000
    ds_write_b128 v32, v[76:79] offset:480
    s_mov_b32 exec_lo, 0x0
    s_mov_b32 exec_hi, 0x3ff0000
    ds_write_b128 v32, v[80:83] offset:640
    s_mov_b32 exec_lo, 0x0
    s_mov_b32 exec_hi, 0x3ff0000
    ds_write_b128 v32, v[84:87] offset:800
    s_mov_b32 exec_lo, 0x0
    s_mov_b32 exec_hi, 0x3ff0000
    ds_write_b128 v32, v[88:91] offset:960
    s_mov_b32 exec_lo, 0x0
    s_mov_b32 exec_hi, 0x3ff0000
    ds_write_b128 v32, v[92:95] offset:1120
    s_mov_b32 exec_lo, 0x0
    s_mov_b32 exec_hi, 0x3ff03ff
    ds_write_b128 v32, v[96:99] offset:1280
    s_mov_b32 exec_lo, 0x0
    s_mov_b32 exec_hi, 0x3ff03ff
    ds_write_b128 v32, v[100:103] offset:1440
    s_mov_b32 exec_lo, 0x0
    s_mov_b32 exec_hi, 0x3ff03ff
    ds_write_b128 v32, v[104:107] offset:1600
    s_mov_b32 exec_lo, 0x0
    s_mov_b32 exec_hi, 0x3ff03ff
    ds_write_b128 v32, v[108:111] offset:1760
    s_mov_b64 exec, -1
    s_waitcnt lgkmcnt(0)
    ds_read_u16 v236, v34 offset:0
    ds_read_u16 v20, v34 offset:160
    ds_read_u16 v237, v34 offset:320
    ds_read_u16 v21, v34 offset:480
    ds_read_u16 v238, v34 offset:32
    ds_read_u16 v22, v34 offset:192
    ds_read_u16 v239, v34 offset:352
    ds_read_u16 v23, v34 offset:512
    ds_read_u16 v240, v34 offset:64
    ds_read_u16 v24, v34 offset:224
    ds_read_u16 v241, v34 offset:384
    ds_read_u16 v25, v34 offset:544
    s_waitcnt lgkmcnt(0)
    v_lshl_or_b32 v236, v20, 16, v236
    v_lshl_or_b32 v237, v21, 16, v237
    v_lshl_or_b32 v238, v22, 16, v238
    v_lshl_or_b32 v239, v23, 16, v239
    v_lshl_or_b32 v240, v24, 16, v240
    v_lshl_or_b32 v241, v25, 16, v241
    ds_read_u16 v242, v34 offset:96
    ds_read_u16 v20, v34 offset:256
    ds_read_u16 v243, v34 offset:416
    ds_read_u16 v21, v34 offset:576
    ds_read_u16 v244, v34 offset:128
    ds_read_u16 v22, v34 offset:288
    ds_read_u16 v245, v34 offset:448
    ds_read_u16 v23, v34 offset:608
    s_waitcnt lgkmcnt(0)
    v_lshl_or_b32 v242, v20, 16, v242
    v_lshl_or_b32 v243, v21, 16, v243
    v_lshl_or_b32 v244, v22, 16, v244
    v_lshl_or_b32 v245, v23, 16, v245
    v_and_b32 v29, 1, v2
    v_lshlrev_b32 v29, 2, v29
    v_and_b32 v27, 3, v3
    v_or_b32 v29, v29, v27
    v_lshlrev_b32 v29, 10, v29
    v_add_u32 v29, 192, v29
    v_and_b32 v27, 7, v3
    v_lshlrev_b32 v27, 10, v27
    v_lshl_add_u32 v40, v2, 4, v27
    v_add_u32 v41, 64, v40
    v_add_u32 v26, 128, v40
    v_cmp_le_u32 vcc, 8, v3
    s_nop 1
    v_cndmask_b32 v40, v40, v26, vcc
    v_cndmask_b32 v41, v41, v29, vcc
    s_lshl_b32 s57, s3, 8
    v_add_u32 v40, s57, v40
    v_add_u32 v41, s57, v41
    v_lshlrev_b32 v42, 6, v2
    v_lshl_add_u32 v42, v3, 2, v42
    s_lshl_b32 s57, s3, 10
    s_add_u32 s57, s57, 7168
    v_add_u32 v42, s57, v42
    v_lshlrev_b32 v43, 4, v0
    s_lshl_b32 s44, s54, 13
    s_add_u32 s44, s44, 851968
    s_mov_b32 s57, 0xffffff00
    v_lshrrev_b32 v45, 1, v2
    v_and_b32 v46, 1, v2
    v_lshl_add_u32 v46, v3, 1, v46
    v_lshrrev_b32 v47, 2, v46
    v_and_b32 v46, 3, v46
    v_lshlrev_b32 v44, 4, v46
    v_lshl_add_u32 v46, v47, 1, v45
    v_lshl_add_u32 v44, v46, 6, v44
    v_lshlrev_b32 v44, 4, v0
    s_mul_i32 s46, s52, 4096
    s_lshr_b32 s45, s54, 2
    s_mul_i32 s45, s45, 32768
    s_add_u32 s46, s46, s45
    s_and_b32 s45, s54, 3
    s_mul_i32 s45, s45, 640
    s_add_u32 s46, s46, s45
    s_add_u32 s46, s46, 1572864
    s_bfe_u32 s47, s2, 0x30001
    s_mul_i32 s47, s47, 4096
    s_lshr_b32 s45, s2, 4
    s_lshl_b32 s45, s45, 7
    s_add_u32 s47, s47, s45
    s_and_b32 s45, s2, 1
    s_lshl_b32 s45, s45, 6
    s_add_u32 s47, s47, s45
    s_add_u32 s47, s47, 1572864
    v_lshrrev_b32 v45, 4, v0
    v_mul_u32_u24 v45, 32768, v45
    v_bfe_u32 v46, v0, 2, 2
    v_mul_u32_u24 v46, 640, v46
    v_add_u32 v45, v45, v46
    v_and_b32 v46, 3, v0
    v_lshl_add_u32 v45, v46, 4, v45
    v_add_u32 v46, 131072, v45
    s_xor_b32 s45, s52, 2
    s_sub_u32 s45, s45, s52
    s_lshl_b32 s45, s45, 12
    s_add_u32 s48, s46, s45
    s_add_u32 s48, s48, 262144
    s_bfe_u32 s50, s2, 0x30001
    s_xor_b32 s45, s50, 2
    s_sub_u32 s45, s45, s50
    s_lshl_b32 s45, s45, 12
    s_add_u32 s45, s45, 262144
    s_add_u32 s49, s47, s45
    s_cmp_eq_u32 s3, 1
    s_cbranch_scc0 L_nopr
    s_cmp_lt_u32 s2, 80
    s_cbranch_scc0 L_nopr
    s_lshl_b32 s85, s50, 12
    s_and_b32 s88, s2, 1
    s_lshl_b32 s88, s88, 17
    s_add_u32 s85, s85, s88
    s_lshr_b32 s88, s2, 4
    s_lshl_b32 s88, s88, 7
    s_add_u32 s85, s85, s88
    s_add_u32 s85, s85, 1575424
    s_mov_b32 s86, -1
    s_mov_b32 s87, -1
    s_mov_b32 s88, s85
    s_memtime s[80:81]
    s_waitcnt lgkmcnt(0)
    s_load_dword s84, s[30:31], s88 glc
    s_waitcnt lgkmcnt(0)
    s_memtime s[82:83]
    s_waitcnt lgkmcnt(0)
    s_sub_u32 s82, s82, s80
    s_min_u32 s86, s86, s82
    s_add_u32 s88, s85, s45
    s_memtime s[80:81]
    s_waitcnt lgkmcnt(0)
    s_load_dword s84, s[30:31], s88 glc
    s_waitcnt lgkmcnt(0)
    s_memtime s[82:83]
    s_waitcnt lgkmcnt(0)
    s_sub_u32 s82, s82, s80
    s_min_u32 s87, s87, s82
    s_add_u32 s85, s85, 32768
    s_mov_b32 s88, s85
    s_memtime s[80:81]
    s_waitcnt lgkmcnt(0)
    s_load_dword s84, s[30:31], s88 glc
    s_waitcnt lgkmcnt(0)
    s_memtime s[82:83]
    s_waitcnt lgkmcnt(0)
    s_sub_u32 s82, s82, s80
    s_min_u32 s86, s86, s82
    s_add_u32 s88, s85, s45
    s_memtime s[80:81]
    s_waitcnt lgkmcnt(0)
    s_load_dword s84, s[30:31], s88 glc
    s_waitcnt lgkmcnt(0)
    s_memtime s[82:83]
    s_waitcnt lgkmcnt(0)
    s_sub_u32 s82, s82, s80
    s_min_u32 s87, s87, s82
    s_add_u32 s85, s85, 32768
    s_mov_b32 s88, s85
    s_memtime s[80:81]
    s_waitcnt lgkmcnt(0)
    s_load_dword s84, s[30:31], s88 glc
    s_waitcnt lgkmcnt(0)
    s_memtime s[82:83]
    s_waitcnt lgkmcnt(0)
    s_sub_u32 s82, s82, s80
    s_min_u32 s86, s86, s82
    s_add_u32 s88, s85, s45
    s_memtime s[80:81]
    s_waitcnt lgkmcnt(0)
    s_load_dword s84, s[30:31], s88 glc
    s_waitcnt lgkmcnt(0)
    s_memtime s[82:83]
    s_waitcnt lgkmcnt(0)
    s_sub_u32 s82, s82, s80
    s_min_u32 s87, s87, s82
    s_add_u32 s85, s85, 32768
    s_mov_b32 s88, s85
    s_memtime s[80:81]
    s_waitcnt lgkmcnt(0)
    s_load_dword s84, s[30:31], s88 glc
    s_waitcnt lgkmcnt(0)
    s_memtime s[82:83]
    s_waitcnt lgkmcnt(0)
    s_sub_u32 s82, s82, s80
    s_min_u32 s86, s86, s82
    s_add_u32 s88, s85, s45
    s_memtime s[80:81]
    s_waitcnt lgkmcnt(0)
    s_load_dword s84, s[30:31], s88 glc
    s_waitcnt lgkmcnt(0)
    s_memtime s[82:83]
    s_waitcnt lgkmcnt(0)
    s_sub_u32 s82, s82, s80
    s_min_u32 s87, s87, s82
    s_add_u32 s85, s85, 32768
    s_cmp_le_u32 s86, s87
    s_cselect_b32 s47, s47, s49
L_nopr:
    s_waitcnt vmcnt(0)
    s_barrier
    s_barrier
    s_mov_b32 s55, 200000
L_opoll_7:
    buffer_load_dwordx4 v[192:195], v40, s[40:43], s44 offen offset:0 sc1
    buffer_load_dwordx4 v[196:199], v41, s[40:43], s44 offen offset:0 sc1
    s_waitcnt vmcnt(0)
    v_msad_u8 v24, v192, s53, 0
    v_msad_u8 v25, v196, s53, 0
    v_msad_u8 v24, v193, s53, v24
    v_msad_u8 v25, v197, s53, v25
    v_msad_u8 v24, v194, s53, v24
    v_msad_u8 v25, v198, s53, v25
    v_msad_u8 v24, v195, s53, v24
    v_msad_u8 v25, v199, s53, v25
    v_or_b32 v24, v24, v25
    v_cmp_ne_u32 vcc, 0, v24
    s_mov_b64 exec, vcc
    s_cbranch_vccz L_done_8
    s_sub_u32 s55, s55, 1
    s_cbranch_scc0 L_opoll_7
L_done_8:
    s_mov_b64 exec, -1
    v_cvt_pk_bf16_f32 v8, v192, v193
    v_cvt_pk_bf16_f32 v9, v194, v195
    v_cvt_pk_bf16_f32 v10, v196, v197
    v_cvt_pk_bf16_f32 v11, v198, v199
    v_and_b32 v14, s57, v196
    v_and_b32 v15, s57, v197
    v_mov_b32_dpp v12, v8 row_ror:8 row_mask:0xf bank_mask:0xf
    v_mov_b32_dpp v13, v9 row_ror:8 row_mask:0xf bank_mask:0xf
    v_mfma_f32_16x16x32_bf16 v[160:163], v[8:11], v[216:219], 0
    v_max_f32_dpp v24, v14, v14 quad_perm:[1,0,3,2] row_mask:0xf bank_mask:0xf
    v_mfma_f32_16x16x32_bf16 v[164:167], v[8:11], v[220:223], 0
    s_nop 0
    v_max_f32_dpp v24, v24, v24 quad_perm:[2,3,0,1] row_mask:0xf bank_mask:0xf
    v_mfma_f32_16x16x32_bf16 v[168:171], v[8:11], v[224:227], 0
    v_sub_f32 v24, v14, v24
    v_mul_f32 v24, 0x3fb8aa3b, v24
    v_mfma_f32_16x16x32_bf16 v[172:175], v[8:11], v[228:231], 0
    v_exp_f32 v24, v24
    v_mfma_f32_16x16x32_bf16 v[176:179], v[8:11], v[232:235], 0
    v_mul_f32 v25, v24, v15
    v_mfma_f32_16x16x16_bf16 v[160:163], v[12:13], v[236:237], v[160:163]
    s_nop 0
    v_add_f32_dpp v25, v25, v25 quad_perm:[1,0,3,2] row_mask:0xf bank_mask:0xf
    v_mfma_f32_16x16x16_bf16 v[164:167], v[12:13], v[238:239], v[164:167]
    s_nop 0
    v_add_f32_dpp v25, v25, v25 quad_perm:[2,3,0,1] row_mask:0xf bank_mask:0xf
    v_mfma_f32_16x16x16_bf16 v[168:171], v[12:13], v[240:241], v[168:171]
    v_rcp_f32 v25, v25
    v_mfma_f32_16x16x16_bf16 v[172:175], v[12:13], v[242:243], v[172:175]
    v_mul_f32 v24, v24, v25
    v_mfma_f32_16x16x16_bf16 v[176:179], v[12:13], v[244:245], v[176:179]
    s_nop 0
    v_mov_b32_dpp v16, v24 row_newbcast:8 row_mask:0xf bank_mask:0xf
    v_mov_b32_dpp v17, v24 row_newbcast:9 row_mask:0xf bank_mask:0xf
    v_mov_b32_dpp v18, v24 row_newbcast:10 row_mask:0xf bank_mask:0xf
    v_mov_b32_dpp v19, v24 row_newbcast:11 row_mask:0xf bank_mask:0xf
    v_pk_fma_f32 v[180:181], v[160:161], v[16:17], v[180:181]
    v_pk_fma_f32 v[182:183], v[164:165], v[16:17], v[182:183]
    v_pk_fma_f32 v[184:185], v[168:169], v[16:17], v[184:185]
    v_pk_fma_f32 v[186:187], v[172:173], v[16:17], v[186:187]
    v_pk_fma_f32 v[188:189], v[176:177], v[16:17], v[188:189]
    v_pk_fma_f32 v[180:181], v[162:163], v[18:19], v[180:181]
    v_pk_fma_f32 v[182:183], v[166:167], v[18:19], v[182:183]
    v_pk_fma_f32 v[184:185], v[170:171], v[18:19], v[184:185]
    v_pk_fma_f32 v[186:187], v[174:175], v[18:19], v[186:187]
    v_pk_fma_f32 v[188:189], v[178:179], v[18:19], v[188:189]
    v_add_f32 v180, v180, v181
    v_add_f32 v182, v182, v183
    v_add_f32 v184, v184, v185
    v_add_f32 v186, v186, v187
    v_add_f32 v188, v188, v189
    s_mov_b32 exec_hi, 0
    ds_write2_b32 v42, v180, v182 offset0:64 offset1:96
    ds_write2_b32 v42, v184, v186 offset0:128 offset1:160
    ds_write_b32 v42, v188 offset:768
    s_mov_b32 exec_hi, -1
    s_waitcnt lgkmcnt(0)
    s_cmp_eq_u32 s3, 0
    s_cbranch_scc1 L_wo3
    s_barrier
    s_cmp_eq_u32 s3, 1
    s_cbranch_scc0 L_Send
    s_cmp_lt_u32 s2, 80
    s_cbranch_scc0 L_Send
    s_mov_b32 s36, s26
    s_mov_b32 s37, s27
    s_mov_b32 s38, 2560
    s_mov_b32 s39, 0x00020000
    s_mov_b32 s44, s47
    buffer_load_dwordx4 v[208:211], v45, s[40:43], s44 offen offset:0 sc1
    buffer_load_dwordx4 v[212:215], v46, s[40:43], s44 offen offset:0 sc1
    buffer_load_dwordx4 v[208:211], v45, s[40:43], s44 offen offset:0 sc1
    buffer_load_dwordx4 v[212:215], v46, s[40:43], s44 offen offset:0 sc1
    s_mov_b32 s55, 200000
L_ypoll_9:
    buffer_load_dwordx4 v[208:211], v45, s[40:43], s44 offen offset:0 sc1
    buffer_load_dwordx4 v[212:215], v46, s[40:43], s44 offen offset:0 sc1
    s_waitcnt vmcnt(4)
    v_msad_u8 v24, v208, s53, 0
    v_msad_u8 v25, v212, s53, 0
    v_msad_u8 v24, v209, s53, v24
    v_msad_u8 v25, v213, s53, v25
    v_msad_u8 v24, v210, s53, v24
    v_msad_u8 v25, v214, s53, v25
    v_msad_u8 v24, v211, s53, v24
    v_msad_u8 v25, v215, s53, v25
    v_or_b32 v24, v24, v25
    v_cmp_ne_u32 vcc, 0, v24
    s_mov_b64 exec, vcc
    s_cbranch_vccz L_done_10
    s_sub_u32 s55, s55, 1
    s_cbranch_scc0 L_ypoll_9
L_done_10:
    s_mov_b64 exec, -1
    v_and_b32 v8, 0xffffff00, v208
    v_and_b32 v9, 0xffffff00, v209
    v_and_b32 v10, 0xffffff00, v210
    v_and_b32 v11, 0xffffff00, v211
    v_and_b32 v12, 0xffffff00, v212
    v_and_b32 v13, 0xffffff00, v213
    v_and_b32 v14, 0xffffff00, v214
    v_and_b32 v15, 0xffffff00, v215
    v_pk_add_f32 v[8:9], v[8:9], v[12:13]
    v_pk_add_f32 v[10:11], v[10:11], v[14:15]
    v_lshlrev_b32 v63, 16, v63
    v_permlane32_swap_b32 v8, v9
    v_permlane32_swap_b32 v10, v11
    v_add_f32 v8, v8, v9
    v_add_f32 v10, v10, v11
    s_nop 1
    v_permlane16_swap_b32 v8, v10
    v_add_f32 v8, v8, v10
    s_nop 1
    v_add_f32_dpp v8, v8, v8 row_ror:8 row_mask:0xf bank_mask:0xf
    s_nop 1
    v_add_f32_dpp v8, v8, v8 row_ror:4 row_mask:0xf bank_mask:0xf
    v_add_f32 v8, v8, v63
    v_cvt_pk_bf16_f32 v8, v8, v8
    s_mov_b32 exec_lo, 0x000f000f
    s_mov_b32 exec_hi, 0x000f000f
    buffer_store_short v8, v62, s[36:39], s60 offen
    s_cmp_eq_u32 s2, 0
    s_cbranch_scc0 L_Sfin
    s_add_u32 s59, s6, 1
    s_mov_b64 exec, 1
    v_mov_b32 v9, s59
    v_mov_b32 v10, 0
    buffer_store_dword v9, v10, s[40:43], 0 offen sc1
L_Sfin:
    s_waitcnt vmcnt(0)
L_Send:
    s_endpgm
L_wo3:
    v_mov_b32 v9, s53
    s_barrier
    ds_read_b128 v[12:15], v43 offset:7424
    ds_read_b128 v[16:19], v43 offset:8448
    ds_read_b128 v[20:23], v43 offset:9472
    ds_read_b128 v[24:27], v43 offset:10496
    s_waitcnt lgkmcnt(2)
    v_pk_add_f32 v[12:13], v[12:13], v[16:17]
    v_pk_add_f32 v[14:15], v[14:15], v[18:19]
    s_waitcnt lgkmcnt(0)
    v_pk_add_f32 v[20:21], v[20:21], v[24:25]
    v_pk_add_f32 v[22:23], v[22:23], v[26:27]
    v_pk_add_f32 v[12:13], v[12:13], v[20:21]
    v_pk_add_f32 v[14:15], v[14:15], v[22:23]
    v_and_or_b32 v12, v12, s57, v9
    v_and_or_b32 v13, v13, s57, v9
    v_and_or_b32 v14, v14, s57, v9
    v_and_or_b32 v15, v15, s57, v9
    s_mov_b32 exec_lo, -1
    s_mov_b32 exec_hi, 0xff
    buffer_store_dwordx4 v[12:15], v44, s[40:43], s46 offen sc1
    buffer_store_dwordx4 v[12:15], v44, s[40:43], s48 offen sc1
    s_waitcnt vmcnt(0)
    s_endpgm
L_T:
    s_sub_u32 s59, s3, 4
    s_lshl_b32 s57, s56, 5
    s_add_u32 s57, s57, s54
    s_lshl_b32 s57, s57, 12
    s_and_b32 s58, s52, 3
    s_lshl_b32 s58, s58, 10
    s_add_u32 s57, s57, s58
    s_lshl_b32 s58, s59, 8
    s_add_u32 s57, s57, s58
    s_mul_i32 s57, s57, 384
    v_mul_u32_u24 v4, 768, v2
    v_lshl_add_u32 v10, v3, 4, v4
    v_lshrrev_b32 v6, 3, v3
    v_mul_u32_u24 v6, 384, v6
    v_and_b32 v7, 7, v3
    v_lshlrev_b32 v7, 4, v7
    v_add3_u32 v5, v4, v6, v7
    v_add_u32 v5, 256, v5
    v_mov_b32 v4, v10
    s_waitcnt lgkmcnt(0)
    s_load_dword s6, s[30:31], 0
    s_add_u32 s32, s10, s57
    s_addc_u32 s33, s11, 0
    s_mov_b32 s34, 98304
    s_mov_b32 s35, 0x00020000
    s_add_u32 s36, s12, s57
    s_addc_u32 s37, s13, 0
    s_mov_b32 s38, 98304
    s_mov_b32 s39, 0x00020000
    s_mov_b32 s40, s30
    s_mov_b32 s41, s31
    s_mov_b32 s42, 4194304
    s_mov_b32 s43, 0x00020000
    s_getreg_b32 s57, hwreg(HW_REG_XCC_ID)
    s_and_b32 s57, s57, 1
    s_cmp_eq_u32 s57, 1
    s_cbranch_scc1 L_Todd
    s_barrier
    s_mov_b32 s44, 0
    buffer_load_dwordx4 v[84:87], v4, s[32:35], s44 offen nt
    buffer_load_dwordx4 v[88:91], v4, s[32:35], s44 offen offset:384 nt
    buffer_load_dwordx4 v[92:95], v5, s[32:35], s44 offen nt
    s_mov_b32 s44, 3072
    buffer_load_dwordx4 v[96:99], v4, s[32:35], s44 offen nt
    buffer_load_dwordx4 v[100:103], v4, s[32:35], s44 offen offset:384 nt
    buffer_load_dwordx4 v[104:107], v5, s[32:35], s44 offen nt
    s_mov_b32 s44, 6144
    s_waitcnt vmcnt(5)
    buffer_load_dwordx4 v[108:111], v4, s[32:35], s44 offen nt
    s_waitcnt vmcnt(5)
    buffer_load_dwordx4 v[112:115], v4, s[32:35], s44 offen offset:384 nt
    s_waitcnt vmcnt(5)
    buffer_load_dwordx4 v[116:119], v5, s[32:35], s44 offen nt
    s_mov_b32 s44, 9216
    s_waitcnt vmcnt(5)
    buffer_load_dwordx4 v[120:123], v4, s[32:35], s44 offen nt
    s_waitcnt vmcnt(5)
    buffer_load_dwordx4 v[124:127], v4, s[32:35], s44 offen offset:384 nt
    s_waitcnt vmcnt(5)
    buffer_load_dwordx4 v[128:131], v5, s[32:35], s44 offen nt
    s_mov_b32 s44, 12288
    s_waitcnt vmcnt(5)
    buffer_load_dwordx4 v[132:135], v4, s[32:35], s44 offen nt
    s_waitcnt vmcnt(5)
    buffer_load_dwordx4 v[136:139], v4, s[32:35], s44 offen offset:384 nt
    s_waitcnt vmcnt(5)
    buffer_load_dwordx4 v[140:143], v5, s[32:35], s44 offen nt
    s_mov_b32 s44, 15360
    s_waitcnt vmcnt(5)
    buffer_load_dwordx4 v[144:147], v4, s[32:35], s44 offen nt
    s_waitcnt vmcnt(5)
    buffer_load_dwordx4 v[148:151], v4, s[32:35], s44 offen offset:384 nt
    s_waitcnt vmcnt(5)
    buffer_load_dwordx4 v[152:155], v5, s[32:35], s44 offen nt
    s_mov_b32 s44, 18432
    s_waitcnt vmcnt(5)
    buffer_load_dwordx4 v[156:159], v4, s[32:35], s44 offen nt
    s_waitcnt vmcnt(5)
    buffer_load_dwordx4 v[160:163], v4, s[32:35], s44 offen offset:384 nt
    s_waitcnt vmcnt(5)
    buffer_load_dwordx4 v[164:167], v5, s[32:35], s44 offen nt
    s_mov_b32 s44, 21504
    s_waitcnt vmcnt(5)
    buffer_load_dwordx4 v[168:171], v4, s[32:35], s44 offen nt
    s_waitcnt vmcnt(5)
    buffer_load_dwordx4 v[172:175], v4, s[32:35], s44 offen offset:384 nt
    s_waitcnt vmcnt(5)
    buffer_load_dwordx4 v[176:179], v5, s[32:35], s44 offen nt
    s_mov_b32 s44, 24576
    s_waitcnt vmcnt(5)
    buffer_load_dwordx4 v[180:183], v4, s[32:35], s44 offen nt
    s_waitcnt vmcnt(5)
    buffer_load_dwordx4 v[184:187], v4, s[32:35], s44 offen offset:384 nt
    s_waitcnt vmcnt(5)
    buffer_load_dwordx4 v[188:191], v5, s[32:35], s44 offen nt
    s_mov_b32 s44, 27648
    s_waitcnt vmcnt(5)
    buffer_load_dwordx4 v[192:195], v4, s[32:35], s44 offen nt
    s_waitcnt vmcnt(5)
    buffer_load_dwordx4 v[196:199], v4, s[32:35], s44 offen offset:384 nt
    s_waitcnt vmcnt(5)
    buffer_load_dwordx4 v[200:203], v5, s[32:35], s44 offen nt
    s_mov_b32 s44, 30720
    s_waitcnt vmcnt(5)
    buffer_load_dwordx4 v[204:207], v4, s[32:35], s44 offen nt
    s_waitcnt vmcnt(5)
    buffer_load_dwordx4 v[208:211], v4, s[32:35], s44 offen offset:384 nt
    s_waitcnt vmcnt(5)
    buffer_load_dwordx4 v[212:215], v5, s[32:35], s44 offen nt
    s_mov_b32 s44, 33792
    s_waitcnt vmcnt(5)
    buffer_load_dwordx4 v[216:219], v4, s[32:35], s44 offen nt
    s_waitcnt vmcnt(5)
    buffer_load_dwordx4 v[220:223], v4, s[32:35], s44 offen offset:384 nt
    s_waitcnt vmcnt(5)
    buffer_load_dwordx4 v[224:227], v5, s[32:35], s44 offen nt
    s_mov_b32 s44, 36864
    s_waitcnt vmcnt(5)
    buffer_load_dwordx4 v[228:231], v4, s[32:35], s44 offen nt
    s_waitcnt vmcnt(5)
    buffer_load_dwordx4 v[232:235], v4, s[32:35], s44 offen offset:384 nt
    s_waitcnt vmcnt(5)
    buffer_load_dwordx4 v[236:239], v5, s[32:35], s44 offen nt
    s_mov_b32 s44, 39936
    s_waitcnt vmcnt(5)
    buffer_load_dwordx4 v[240:243], v4, s[32:35], s44 offen nt
    s_waitcnt vmcnt(5)
    buffer_load_dwordx4 v[244:247], v4, s[32:35], s44 offen offset:384 nt
    s_waitcnt vmcnt(5)
    buffer_load_dwordx4 v[248:251], v5, s[32:35], s44 offen nt
    v_and_b32 v10, 1, v3
    v_cmp_eq_u32 vcc, 1, v10
    v_mov_b32 v11, 0xffff
    v_mov_b32 v10, 0xffff0000
    v_cndmask_b32 v11, v11, v10, vcc
    v_bfe_u32 v10, v3, 1, 2
    v_cmp_eq_u32 vcc, 0, v10
    s_nop 1
    v_cndmask_b32 v6, 0, v11, vcc
    v_cmp_eq_u32 vcc, 1, v10
    s_nop 1
    v_cndmask_b32 v7, 0, v11, vcc
    v_cmp_eq_u32 vcc, 2, v10
    s_nop 1
    v_cndmask_b32 v8, 0, v11, vcc
    v_cmp_eq_u32 vcc, 3, v10
    s_nop 1
    v_cndmask_b32 v9, 0, v11, vcc
    v_lshlrev_b32 v10, 4, v3
    v_and_b32 v11, 7, v3
    v_lshlrev_b32 v11, 4, v11
    s_mov_b32 s48, 0x3d93cd3a
    s_mov_b32 s49, 0x3d93cd3a
    s_mov_b32 s50, 0x3fb8aa3b
    s_mov_b32 s51, 0x3fb8aa3b
    v_mov_b32 v30, 0xff800000
    s_barrier
    ds_read_b128 v[12:15], v10 offset:0
    ds_read_b128 v[16:19], v11 offset:256
    s_waitcnt lgkmcnt(0)
    s_waitcnt vmcnt(39)
    v_dot2_f32_bf16 v20, v84, v12, 0
    v_dot2_f32_bf16 v21, v88, v12, 0
    v_dot2_f32_bf16 v22, v92, v16, 0
    v_dot2_f32_bf16 v20, v85, v13, v20
    v_dot2_f32_bf16 v21, v89, v13, v21
    v_dot2_f32_bf16 v22, v93, v17, v22
    v_dot2_f32_bf16 v20, v86, v14, v20
    v_dot2_f32_bf16 v21, v90, v14, v21
    v_dot2_f32_bf16 v22, v94, v18, v22
    v_dot2_f32_bf16 v20, v87, v15, v20
    v_dot2_f32_bf16 v21, v91, v15, v21
    v_dot2_f32_bf16 v22, v95, v19, v22
    s_mov_b32 s44, 43008
    s_waitcnt vmcnt(5)
    buffer_load_dwordx4 v[84:87], v4, s[32:35], s44 offen nt
    s_waitcnt vmcnt(5)
    buffer_load_dwordx4 v[88:91], v4, s[32:35], s44 offen offset:384 nt
    s_waitcnt vmcnt(5)
    buffer_load_dwordx4 v[92:95], v5, s[32:35], s44 offen nt
    s_waitcnt vmcnt(39)
    v_dot2_f32_bf16 v23, v96, v12, 0
    v_add_f32_dpp v26, v20, v20 row_ror:8 row_mask:0xf bank_mask:0xf
    v_dot2_f32_bf16 v24, v100, v12, 0
    v_dot2_f32_bf16 v25, v104, v16, 0
    v_add_f32_dpp v26, v21, v21 row_ror:8 row_mask:0xf bank_mask:0xc
    v_dot2_f32_bf16 v23, v97, v13, v23
    v_dot2_f32_bf16 v24, v101, v13, v24
    v_add_f32 v26, v26, v22
    v_dot2_f32_bf16 v25, v105, v17, v25
    v_dot2_f32_bf16 v23, v98, v14, v23
    v_add_f32_dpp v26, v26, v26 quad_perm:[1,0,3,2] row_mask:0xf bank_mask:0xf
    v_dot2_f32_bf16 v24, v102, v14, v24
    v_dot2_f32_bf16 v25, v106, v18, v25
    v_add_f32_dpp v26, v26, v26 quad_perm:[2,3,0,1] row_mask:0xf bank_mask:0xf
    v_dot2_f32_bf16 v23, v99, v15, v23
    v_dot2_f32_bf16 v24, v103, v15, v24
    v_add_f32_dpp v26, v26, v26 row_half_mirror row_mask:0xf bank_mask:0xf
    v_dot2_f32_bf16 v25, v107, v19, v25
    s_mov_b32 s44, 46080
    s_waitcnt vmcnt(5)
    buffer_load_dwordx4 v[96:99], v4, s[32:35], s44 offen nt
    s_waitcnt vmcnt(5)
    buffer_load_dwordx4 v[100:103], v4, s[32:35], s44 offen offset:384 nt
    s_waitcnt vmcnt(5)
    buffer_load_dwordx4 v[104:107], v5, s[32:35], s44 offen nt
    s_waitcnt vmcnt(39)
    v_dot2_f32_bf16 v20, v108, v12, 0
    v_add_f32_dpp v27, v23, v23 row_ror:8 row_mask:0xf bank_mask:0xf
    v_dot2_f32_bf16 v21, v112, v12, 0
    v_dot2_f32_bf16 v22, v116, v16, 0
    v_add_f32_dpp v27, v24, v24 row_ror:8 row_mask:0xf bank_mask:0xc
    v_dot2_f32_bf16 v20, v109, v13, v20
    v_dot2_f32_bf16 v21, v113, v13, v21
    v_add_f32 v27, v27, v25
    v_dot2_f32_bf16 v22, v117, v17, v22
    v_dot2_f32_bf16 v20, v110, v14, v20
    v_add_f32_dpp v27, v27, v27 quad_perm:[1,0,3,2] row_mask:0xf bank_mask:0xf
    v_dot2_f32_bf16 v21, v114, v14, v21
    v_dot2_f32_bf16 v22, v118, v18, v22
    v_add_f32_dpp v27, v27, v27 quad_perm:[2,3,0,1] row_mask:0xf bank_mask:0xf
    v_dot2_f32_bf16 v20, v111, v15, v20
    v_dot2_f32_bf16 v21, v115, v15, v21
    v_add_f32_dpp v27, v27, v27 row_half_mirror row_mask:0xf bank_mask:0xf
    v_dot2_f32_bf16 v22, v119, v19, v22
    s_mov_b32 s44, 49152
    s_waitcnt vmcnt(5)
    buffer_load_dwordx4 v[108:111], v4, s[32:35], s44 offen nt
    s_waitcnt vmcnt(5)
    buffer_load_dwordx4 v[112:115], v4, s[32:35], s44 offen offset:384 nt
    s_waitcnt vmcnt(5)
    buffer_load_dwordx4 v[116:119], v5, s[32:35], s44 offen nt
    s_waitcnt vmcnt(39)
    v_cvt_pk_bf16_f32 v31, v26, v27
    v_lshlrev_b32 v28, 16, v31
    v_and_b32 v29, 0xffff0000, v31
    v_pk_mul_f32 v[28:29], v[28:29], s[48:49]
    v_cvt_pk_bf16_f32 v31, v28, v29
    v_lshlrev_b32 v52, 16, v31
    v_and_b32 v53, 0xffff0000, v31
    v_max3_f32 v30, v30, v52, v53
    v_dot2_f32_bf16 v23, v120, v12, 0
    v_add_f32_dpp v26, v20, v20 row_ror:8 row_mask:0xf bank_mask:0xf
    v_dot2_f32_bf16 v24, v124, v12, 0
    v_dot2_f32_bf16 v25, v128, v16, 0
    v_add_f32_dpp v26, v21, v21 row_ror:8 row_mask:0xf bank_mask:0xc
    v_dot2_f32_bf16 v23, v121, v13, v23
    v_dot2_f32_bf16 v24, v125, v13, v24
    v_add_f32 v26, v26, v22
    v_dot2_f32_bf16 v25, v129, v17, v25
    v_dot2_f32_bf16 v23, v122, v14, v23
    v_add_f32_dpp v26, v26, v26 quad_perm:[1,0,3,2] row_mask:0xf bank_mask:0xf
    v_dot2_f32_bf16 v24, v126, v14, v24
    v_dot2_f32_bf16 v25, v130, v18, v25
    v_add_f32_dpp v26, v26, v26 quad_perm:[2,3,0,1] row_mask:0xf bank_mask:0xf
    v_dot2_f32_bf16 v23, v123, v15, v23
    v_dot2_f32_bf16 v24, v127, v15, v24
    v_add_f32_dpp v26, v26, v26 row_half_mirror row_mask:0xf bank_mask:0xf
    v_dot2_f32_bf16 v25, v131, v19, v25
    s_mov_b32 s44, 52224
    s_waitcnt vmcnt(5)
    buffer_load_dwordx4 v[120:123], v4, s[32:35], s44 offen nt
    s_waitcnt vmcnt(5)
    buffer_load_dwordx4 v[124:127], v4, s[32:35], s44 offen offset:384 nt
    s_waitcnt vmcnt(5)
    buffer_load_dwordx4 v[128:131], v5, s[32:35], s44 offen nt
    s_waitcnt vmcnt(39)
    v_dot2_f32_bf16 v20, v132, v12, 0
    v_add_f32_dpp v27, v23, v23 row_ror:8 row_mask:0xf bank_mask:0xf
    v_dot2_f32_bf16 v21, v136, v12, 0
    v_dot2_f32_bf16 v22, v140, v16, 0
    v_add_f32_dpp v27, v24, v24 row_ror:8 row_mask:0xf bank_mask:0xc
    v_dot2_f32_bf16 v20, v133, v13, v20
    v_dot2_f32_bf16 v21, v137, v13, v21
    v_add_f32 v27, v27, v25
    v_dot2_f32_bf16 v22, v141, v17, v22
    v_dot2_f32_bf16 v20, v134, v14, v20
    v_add_f32_dpp v27, v27, v27 quad_perm:[1,0,3,2] row_mask:0xf bank_mask:0xf
    v_dot2_f32_bf16 v21, v138, v14, v21
    v_dot2_f32_bf16 v22, v142, v18, v22
    v_add_f32_dpp v27, v27, v27 quad_perm:[2,3,0,1] row_mask:0xf bank_mask:0xf
    v_dot2_f32_bf16 v20, v135, v15, v20
    v_dot2_f32_bf16 v21, v139, v15, v21
    v_add_f32_dpp v27, v27, v27 row_half_mirror row_mask:0xf bank_mask:0xf
    v_dot2_f32_bf16 v22, v143, v19, v22
    s_mov_b32 s44, 55296
    s_waitcnt vmcnt(5)
    buffer_load_dwordx4 v[132:135], v4, s[32:35], s44 offen nt
    s_waitcnt vmcnt(5)
    buffer_load_dwordx4 v[136:139], v4, s[32:35], s44 offen offset:384 nt
    s_waitcnt vmcnt(5)
    buffer_load_dwordx4 v[140:143], v5, s[32:35], s44 offen nt
    s_waitcnt vmcnt(39)
    v_cvt_pk_bf16_f32 v31, v26, v27
    v_lshlrev_b32 v28, 16, v31
    v_and_b32 v29, 0xffff0000, v31
    v_pk_mul_f32 v[28:29], v[28:29], s[48:49]
    v_cvt_pk_bf16_f32 v31, v28, v29
    v_lshlrev_b32 v54, 16, v31
    v_and_b32 v55, 0xffff0000, v31
    v_max3_f32 v30, v30, v54, v55
    v_dot2_f32_bf16 v23, v144, v12, 0
    v_add_f32_dpp v26, v20, v20 row_ror:8 row_mask:0xf bank_mask:0xf
    v_dot2_f32_bf16 v24, v148, v12, 0
    v_dot2_f32_bf16 v25, v152, v16, 0
    v_add_f32_dpp v26, v21, v21 row_ror:8 row_mask:0xf bank_mask:0xc
    v_dot2_f32_bf16 v23, v145, v13, v23
    v_dot2_f32_bf16 v24, v149, v13, v24
    v_add_f32 v26, v26, v22
    v_dot2_f32_bf16 v25, v153, v17, v25
    v_dot2_f32_bf16 v23, v146, v14, v23
    v_add_f32_dpp v26, v26, v26 quad_perm:[1,0,3,2] row_mask:0xf bank_mask:0xf
    v_dot2_f32_bf16 v24, v150, v14, v24
    v_dot2_f32_bf16 v25, v154, v18, v25
    v_add_f32_dpp v26, v26, v26 quad_perm:[2,3,0,1] row_mask:0xf bank_mask:0xf
    v_dot2_f32_bf16 v23, v147, v15, v23
    v_dot2_f32_bf16 v24, v151, v15, v24
    v_add_f32_dpp v26, v26, v26 row_half_mirror row_mask:0xf bank_mask:0xf
    v_dot2_f32_bf16 v25, v155, v19, v25
    s_mov_b32 s44, 58368
    s_waitcnt vmcnt(5)
    buffer_load_dwordx4 v[144:147], v4, s[32:35], s44 offen nt
    s_waitcnt vmcnt(5)
    buffer_load_dwordx4 v[148:151], v4, s[32:35], s44 offen offset:384 nt
    s_waitcnt vmcnt(5)
    buffer_load_dwordx4 v[152:155], v5, s[32:35], s44 offen nt
    s_waitcnt vmcnt(39)
    v_dot2_f32_bf16 v20, v156, v12, 0
    v_add_f32_dpp v27, v23, v23 row_ror:8 row_mask:0xf bank_mask:0xf
    v_dot2_f32_bf16 v21, v160, v12, 0
    v_dot2_f32_bf16 v22, v164, v16, 0
    v_add_f32_dpp v27, v24, v24 row_ror:8 row_mask:0xf bank_mask:0xc
    v_dot2_f32_bf16 v20, v157, v13, v20
    v_dot2_f32_bf16 v21, v161, v13, v21
    v_add_f32 v27, v27, v25
    v_dot2_f32_bf16 v22, v165, v17, v22
    v_dot2_f32_bf16 v20, v158, v14, v20
    v_add_f32_dpp v27, v27, v27 quad_perm:[1,0,3,2] row_mask:0xf bank_mask:0xf
    v_dot2_f32_bf16 v21, v162, v14, v21
    v_dot2_f32_bf16 v22, v166, v18, v22
    v_add_f32_dpp v27, v27, v27 quad_perm:[2,3,0,1] row_mask:0xf bank_mask:0xf
    v_dot2_f32_bf16 v20, v159, v15, v20
    v_dot2_f32_bf16 v21, v163, v15, v21
    v_add_f32_dpp v27, v27, v27 row_half_mirror row_mask:0xf bank_mask:0xf
    v_dot2_f32_bf16 v22, v167, v19, v22
    s_mov_b32 s44, 61440
    s_waitcnt vmcnt(5)
    buffer_load_dwordx4 v[156:159], v4, s[32:35], s44 offen nt
    s_waitcnt vmcnt(5)
    buffer_load_dwordx4 v[160:163], v4, s[32:35], s44 offen offset:384 nt
    s_waitcnt vmcnt(5)
    buffer_load_dwordx4 v[164:167], v5, s[32:35], s44 offen nt
    s_waitcnt vmcnt(39)
    v_cvt_pk_bf16_f32 v31, v26, v27
    v_lshlrev_b32 v28, 16, v31
    v_and_b32 v29, 0xffff0000, v31
    v_pk_mul_f32 v[28:29], v[28:29], s[48:49]
    v_cvt_pk_bf16_f32 v31, v28, v29
    v_lshlrev_b32 v56, 16, v31
    v_and_b32 v57, 0xffff0000, v31
    v_max3_f32 v30, v30, v56, v57
    v_dot2_f32_bf16 v23, v168, v12, 0
    v_add_f32_dpp v26, v20, v20 row_ror:8 row_mask:0xf bank_mask:0xf
    v_dot2_f32_bf16 v24, v172, v12, 0
    v_dot2_f32_bf16 v25, v176, v16, 0
    v_add_f32_dpp v26, v21, v21 row_ror:8 row_mask:0xf bank_mask:0xc
    v_dot2_f32_bf16 v23, v169, v13, v23
    v_dot2_f32_bf16 v24, v173, v13, v24
    v_add_f32 v26, v26, v22
    v_dot2_f32_bf16 v25, v177, v17, v25
    v_dot2_f32_bf16 v23, v170, v14, v23
    v_add_f32_dpp v26, v26, v26 quad_perm:[1,0,3,2] row_mask:0xf bank_mask:0xf
    v_dot2_f32_bf16 v24, v174, v14, v24
    v_dot2_f32_bf16 v25, v178, v18, v25
    v_add_f32_dpp v26, v26, v26 quad_perm:[2,3,0,1] row_mask:0xf bank_mask:0xf
    v_dot2_f32_bf16 v23, v171, v15, v23
    v_dot2_f32_bf16 v24, v175, v15, v24
    v_add_f32_dpp v26, v26, v26 row_half_mirror row_mask:0xf bank_mask:0xf
    v_dot2_f32_bf16 v25, v179, v19, v25
    s_mov_b32 s44, 64512
    s_waitcnt vmcnt(5)
    buffer_load_dwordx4 v[168:171], v4, s[32:35], s44 offen nt
    s_waitcnt vmcnt(5)
    buffer_load_dwordx4 v[172:175], v4, s[32:35], s44 offen offset:384 nt
    s_waitcnt vmcnt(5)
    buffer_load_dwordx4 v[176:179], v5, s[32:35], s44 offen nt
    s_waitcnt vmcnt(39)
    v_dot2_f32_bf16 v20, v180, v12, 0
    v_add_f32_dpp v27, v23, v23 row_ror:8 row_mask:0xf bank_mask:0xf
    v_dot2_f32_bf16 v21, v184, v12, 0
    v_dot2_f32_bf16 v22, v188, v16, 0
    v_add_f32_dpp v27, v24, v24 row_ror:8 row_mask:0xf bank_mask:0xc
    v_dot2_f32_bf16 v20, v181, v13, v20
    v_dot2_f32_bf16 v21, v185, v13, v21
    v_add_f32 v27, v27, v25
    v_dot2_f32_bf16 v22, v189, v17, v22
    v_dot2_f32_bf16 v20, v182, v14, v20
    v_add_f32_dpp v27, v27, v27 quad_perm:[1,0,3,2] row_mask:0xf bank_mask:0xf
    v_dot2_f32_bf16 v21, v186, v14, v21
    v_dot2_f32_bf16 v22, v190, v18, v22
    v_add_f32_dpp v27, v27, v27 quad_perm:[2,3,0,1] row_mask:0xf bank_mask:0xf
    v_dot2_f32_bf16 v20, v183, v15, v20
    v_dot2_f32_bf16 v21, v187, v15, v21
    v_add_f32_dpp v27, v27, v27 row_half_mirror row_mask:0xf bank_mask:0xf
    v_dot2_f32_bf16 v22, v191, v19, v22
    s_mov_b32 s44, 67584
    s_waitcnt vmcnt(5)
    buffer_load_dwordx4 v[180:183], v4, s[32:35], s44 offen nt
    s_waitcnt vmcnt(5)
    buffer_load_dwordx4 v[184:187], v4, s[32:35], s44 offen offset:384 nt
    s_waitcnt vmcnt(5)
    buffer_load_dwordx4 v[188:191], v5, s[32:35], s44 offen nt
    s_waitcnt vmcnt(39)
    v_cvt_pk_bf16_f32 v31, v26, v27
    v_lshlrev_b32 v28, 16, v31
    v_and_b32 v29, 0xffff0000, v31
    v_pk_mul_f32 v[28:29], v[28:29], s[48:49]
    v_cvt_pk_bf16_f32 v31, v28, v29
    v_lshlrev_b32 v58, 16, v31
    v_and_b32 v59, 0xffff0000, v31
    v_max3_f32 v30, v30, v58, v59
    v_dot2_f32_bf16 v23, v192, v12, 0
    v_add_f32_dpp v26, v20, v20 row_ror:8 row_mask:0xf bank_mask:0xf
    v_dot2_f32_bf16 v24, v196, v12, 0
    v_dot2_f32_bf16 v25, v200, v16, 0
    v_add_f32_dpp v26, v21, v21 row_ror:8 row_mask:0xf bank_mask:0xc
    v_dot2_f32_bf16 v23, v193, v13, v23
    v_dot2_f32_bf16 v24, v197, v13, v24
    v_add_f32 v26, v26, v22
    v_dot2_f32_bf16 v25, v201, v17, v25
    v_dot2_f32_bf16 v23, v194, v14, v23
    v_add_f32_dpp v26, v26, v26 quad_perm:[1,0,3,2] row_mask:0xf bank_mask:0xf
    v_dot2_f32_bf16 v24, v198, v14, v24
    v_dot2_f32_bf16 v25, v202, v18, v25
    v_add_f32_dpp v26, v26, v26 quad_perm:[2,3,0,1] row_mask:0xf bank_mask:0xf
    v_dot2_f32_bf16 v23, v195, v15, v23
    v_dot2_f32_bf16 v24, v199, v15, v24
    v_add_f32_dpp v26, v26, v26 row_half_mirror row_mask:0xf bank_mask:0xf
    v_dot2_f32_bf16 v25, v203, v19, v25
    s_mov_b32 s44, 70656
    s_waitcnt vmcnt(5)
    buffer_load_dwordx4 v[192:195], v4, s[32:35], s44 offen nt
    s_waitcnt vmcnt(5)
    buffer_load_dwordx4 v[196:199], v4, s[32:35], s44 offen offset:384 nt
    s_waitcnt vmcnt(5)
    buffer_load_dwordx4 v[200:203], v5, s[32:35], s44 offen nt
    s_waitcnt vmcnt(39)
    v_dot2_f32_bf16 v20, v204, v12, 0
    v_add_f32_dpp v27, v23, v23 row_ror:8 row_mask:0xf bank_mask:0xf
    v_dot2_f32_bf16 v21, v208, v12, 0
    v_dot2_f32_bf16 v22, v212, v16, 0
    v_add_f32_dpp v27, v24, v24 row_ror:8 row_mask:0xf bank_mask:0xc
    v_dot2_f32_bf16 v20, v205, v13, v20
    v_dot2_f32_bf16 v21, v209, v13, v21
    v_add_f32 v27, v27, v25
    v_dot2_f32_bf16 v22, v213, v17, v22
    v_dot2_f32_bf16 v20, v206, v14, v20
    v_add_f32_dpp v27, v27, v27 quad_perm:[1,0,3,2] row_mask:0xf bank_mask:0xf
    v_dot2_f32_bf16 v21, v210, v14, v21
    v_dot2_f32_bf16 v22, v214, v18, v22
    v_add_f32_dpp v27, v27, v27 quad_perm:[2,3,0,1] row_mask:0xf bank_mask:0xf
    v_dot2_f32_bf16 v20, v207, v15, v20
    v_dot2_f32_bf16 v21, v211, v15, v21
    v_add_f32_dpp v27, v27, v27 row_half_mirror row_mask:0xf bank_mask:0xf
    v_dot2_f32_bf16 v22, v215, v19, v22
    s_mov_b32 s44, 73728
    s_waitcnt vmcnt(5)
    buffer_load_dwordx4 v[204:207], v4, s[32:35], s44 offen nt
    s_waitcnt vmcnt(5)
    buffer_load_dwordx4 v[208:211], v4, s[32:35], s44 offen offset:384 nt
    s_waitcnt vmcnt(5)
    buffer_load_dwordx4 v[212:215], v5, s[32:35], s44 offen nt
    s_waitcnt vmcnt(39)
    v_cvt_pk_bf16_f32 v31, v26, v27
    v_lshlrev_b32 v28, 16, v31
    v_and_b32 v29, 0xffff0000, v31
    v_pk_mul_f32 v[28:29], v[28:29], s[48:49]
    v_cvt_pk_bf16_f32 v31, v28, v29
    v_lshlrev_b32 v60, 16, v31
    v_and_b32 v61, 0xffff0000, v31
    v_max3_f32 v30, v30, v60, v61
    v_dot2_f32_bf16 v23, v216, v12, 0
    v_add_f32_dpp v26, v20, v20 row_ror:8 row_mask:0xf bank_mask:0xf
    v_dot2_f32_bf16 v24, v220, v12, 0
    v_dot2_f32_bf16 v25, v224, v16, 0
    v_add_f32_dpp v26, v21, v21 row_ror:8 row_mask:0xf bank_mask:0xc
    v_dot2_f32_bf16 v23, v217, v13, v23
    v_dot2_f32_bf16 v24, v221, v13, v24
    v_add_f32 v26, v26, v22
    v_dot2_f32_bf16 v25, v225, v17, v25
    v_dot2_f32_bf16 v23, v218, v14, v23
    v_add_f32_dpp v26, v26, v26 quad_perm:[1,0,3,2] row_mask:0xf bank_mask:0xf
    v_dot2_f32_bf16 v24, v222, v14, v24
    v_dot2_f32_bf16 v25, v226, v18, v25
    v_add_f32_dpp v26, v26, v26 quad_perm:[2,3,0,1] row_mask:0xf bank_mask:0xf
    v_dot2_f32_bf16 v23, v219, v15, v23
    v_dot2_f32_bf16 v24, v223, v15, v24
    v_add_f32_dpp v26, v26, v26 row_half_mirror row_mask:0xf bank_mask:0xf
    v_dot2_f32_bf16 v25, v227, v19, v25
    s_mov_b32 s44, 76800
    s_waitcnt vmcnt(5)
    buffer_load_dwordx4 v[216:219], v4, s[32:35], s44 offen nt
    s_waitcnt vmcnt(5)
    buffer_load_dwordx4 v[220:223], v4, s[32:35], s44 offen offset:384 nt
    s_waitcnt vmcnt(5)
    buffer_load_dwordx4 v[224:227], v5, s[32:35], s44 offen nt
    s_waitcnt vmcnt(39)
    v_dot2_f32_bf16 v20, v228, v12, 0
    v_add_f32_dpp v27, v23, v23 row_ror:8 row_mask:0xf bank_mask:0xf
    v_dot2_f32_bf16 v21, v232, v12, 0
    v_dot2_f32_bf16 v22, v236, v16, 0
    v_add_f32_dpp v27, v24, v24 row_ror:8 row_mask:0xf bank_mask:0xc
    v_dot2_f32_bf16 v20, v229, v13, v20
    v_dot2_f32_bf16 v21, v233, v13, v21
    v_add_f32 v27, v27, v25
    v_dot2_f32_bf16 v22, v237, v17, v22
    v_dot2_f32_bf16 v20, v230, v14, v20
    v_add_f32_dpp v27, v27, v27 quad_perm:[1,0,3,2] row_mask:0xf bank_mask:0xf
    v_dot2_f32_bf16 v21, v234, v14, v21
    v_dot2_f32_bf16 v22, v238, v18, v22
    v_add_f32_dpp v27, v27, v27 quad_perm:[2,3,0,1] row_mask:0xf bank_mask:0xf
    v_dot2_f32_bf16 v20, v231, v15, v20
    v_dot2_f32_bf16 v21, v235, v15, v21
    v_add_f32_dpp v27, v27, v27 row_half_mirror row_mask:0xf bank_mask:0xf
    v_dot2_f32_bf16 v22, v239, v19, v22
    s_mov_b32 s44, 79872
    s_waitcnt vmcnt(5)
    buffer_load_dwordx4 v[228:231], v4, s[32:35], s44 offen nt
    s_waitcnt vmcnt(5)
    buffer_load_dwordx4 v[232:235], v4, s[32:35], s44 offen offset:384 nt
    s_waitcnt vmcnt(5)
    buffer_load_dwordx4 v[236:239], v5, s[32:35], s44 offen nt
    s_waitcnt vmcnt(39)
    v_cvt_pk_bf16_f32 v31, v26, v27
    v_lshlrev_b32 v28, 16, v31
    v_and_b32 v29, 0xffff0000, v31
    v_pk_mul_f32 v[28:29], v[28:29], s[48:49]
    v_cvt_pk_bf16_f32 v31, v28, v29
    v_lshlrev_b32 v62, 16, v31
    v_and_b32 v63, 0xffff0000, v31
    v_max3_f32 v30, v30, v62, v63
    v_dot2_f32_bf16 v23, v240, v12, 0
    v_add_f32_dpp v26, v20, v20 row_ror:8 row_mask:0xf bank_mask:0xf
    v_dot2_f32_bf16 v24, v244, v12, 0
    v_dot2_f32_bf16 v25, v248, v16, 0
    v_add_f32_dpp v26, v21, v21 row_ror:8 row_mask:0xf bank_mask:0xc
    v_dot2_f32_bf16 v23, v241, v13, v23
    v_dot2_f32_bf16 v24, v245, v13, v24
    v_add_f32 v26, v26, v22
    v_dot2_f32_bf16 v25, v249, v17, v25
    v_dot2_f32_bf16 v23, v242, v14, v23
    v_add_f32_dpp v26, v26, v26 quad_perm:[1,0,3,2] row_mask:0xf bank_mask:0xf
    v_dot2_f32_bf16 v24, v246, v14, v24
    v_dot2_f32_bf16 v25, v250, v18, v25
    v_add_f32_dpp v26, v26, v26 quad_perm:[2,3,0,1] row_mask:0xf bank_mask:0xf
    v_dot2_f32_bf16 v23, v243, v15, v23
    v_dot2_f32_bf16 v24, v247, v15, v24
    v_add_f32_dpp v26, v26, v26 row_half_mirror row_mask:0xf bank_mask:0xf
    v_dot2_f32_bf16 v25, v251, v19, v25
    s_mov_b32 s44, 82944
    s_waitcnt vmcnt(5)
    buffer_load_dwordx4 v[240:243], v4, s[32:35], s44 offen nt
    s_waitcnt vmcnt(5)
    buffer_load_dwordx4 v[244:247], v4, s[32:35], s44 offen offset:384 nt
    s_waitcnt vmcnt(5)
    buffer_load_dwordx4 v[248:251], v5, s[32:35], s44 offen nt
    s_waitcnt vmcnt(39)
    v_dot2_f32_bf16 v20, v84, v12, 0
    v_add_f32_dpp v27, v23, v23 row_ror:8 row_mask:0xf bank_mask:0xf
    v_dot2_f32_bf16 v21, v88, v12, 0
    v_dot2_f32_bf16 v22, v92, v16, 0
    v_add_f32_dpp v27, v24, v24 row_ror:8 row_mask:0xf bank_mask:0xc
    v_dot2_f32_bf16 v20, v85, v13, v20
    v_dot2_f32_bf16 v21, v89, v13, v21
    v_add_f32 v27, v27, v25
    v_dot2_f32_bf16 v22, v93, v17, v22
    v_dot2_f32_bf16 v20, v86, v14, v20
    v_add_f32_dpp v27, v27, v27 quad_perm:[1,0,3,2] row_mask:0xf bank_mask:0xf
    v_dot2_f32_bf16 v21, v90, v14, v21
    v_dot2_f32_bf16 v22, v94, v18, v22
    v_add_f32_dpp v27, v27, v27 quad_perm:[2,3,0,1] row_mask:0xf bank_mask:0xf
    v_dot2_f32_bf16 v20, v87, v15, v20
    v_dot2_f32_bf16 v21, v91, v15, v21
    v_add_f32_dpp v27, v27, v27 row_half_mirror row_mask:0xf bank_mask:0xf
    v_dot2_f32_bf16 v22, v95, v19, v22
    s_mov_b32 s44, 86016
    s_waitcnt vmcnt(5)
    buffer_load_dwordx4 v[84:87], v4, s[32:35], s44 offen nt
    s_waitcnt vmcnt(5)
    buffer_load_dwordx4 v[88:91], v4, s[32:35], s44 offen offset:384 nt
    s_waitcnt vmcnt(5)
    buffer_load_dwordx4 v[92:95], v5, s[32:35], s44 offen nt
    s_waitcnt vmcnt(39)
    v_cvt_pk_bf16_f32 v31, v26, v27
    v_lshlrev_b32 v28, 16, v31
    v_and_b32 v29, 0xffff0000, v31
    v_pk_mul_f32 v[28:29], v[28:29], s[48:49]
    v_cvt_pk_bf16_f32 v31, v28, v29
    v_lshlrev_b32 v64, 16, v31
    v_and_b32 v65, 0xffff0000, v31
    v_max3_f32 v30, v30, v64, v65
    v_dot2_f32_bf16 v23, v96, v12, 0
    v_add_f32_dpp v26, v20, v20 row_ror:8 row_mask:0xf bank_mask:0xf
    v_dot2_f32_bf16 v24, v100, v12, 0
    v_dot2_f32_bf16 v25, v104, v16, 0
    v_add_f32_dpp v26, v21, v21 row_ror:8 row_mask:0xf bank_mask:0xc
    v_dot2_f32_bf16 v23, v97, v13, v23
    v_dot2_f32_bf16 v24, v101, v13, v24
    v_add_f32 v26, v26, v22
    v_dot2_f32_bf16 v25, v105, v17, v25
    v_dot2_f32_bf16 v23, v98, v14, v23
    v_add_f32_dpp v26, v26, v26 quad_perm:[1,0,3,2] row_mask:0xf bank_mask:0xf
    v_dot2_f32_bf16 v24, v102, v14, v24
    v_dot2_f32_bf16 v25, v106, v18, v25
    v_add_f32_dpp v26, v26, v26 quad_perm:[2,3,0,1] row_mask:0xf bank_mask:0xf
    v_dot2_f32_bf16 v23, v99, v15, v23
    v_dot2_f32_bf16 v24, v103, v15, v24
    v_add_f32_dpp v26, v26, v26 row_half_mirror row_mask:0xf bank_mask:0xf
    v_dot2_f32_bf16 v25, v107, v19, v25
    s_mov_b32 s44, 89088
    s_waitcnt vmcnt(5)
    buffer_load_dwordx4 v[96:99], v4, s[32:35], s44 offen nt
    s_waitcnt vmcnt(5)
    buffer_load_dwordx4 v[100:103], v4, s[32:35], s44 offen offset:384 nt
    s_waitcnt vmcnt(5)
    buffer_load_dwordx4 v[104:107], v5, s[32:35], s44 offen nt
    s_waitcnt vmcnt(39)
    v_dot2_f32_bf16 v20, v108, v12, 0
    v_add_f32_dpp v27, v23, v23 row_ror:8 row_mask:0xf bank_mask:0xf
    v_dot2_f32_bf16 v21, v112, v12, 0
    v_dot2_f32_bf16 v22, v116, v16, 0
    v_add_f32_dpp v27, v24, v24 row_ror:8 row_mask:0xf bank_mask:0xc
    v_dot2_f32_bf16 v20, v109, v13, v20
    v_dot2_f32_bf16 v21, v113, v13, v21
    v_add_f32 v27, v27, v25
    v_dot2_f32_bf16 v22, v117, v17, v22
    v_dot2_f32_bf16 v20, v110, v14, v20
    v_add_f32_dpp v27, v27, v27 quad_perm:[1,0,3,2] row_mask:0xf bank_mask:0xf
    v_dot2_f32_bf16 v21, v114, v14, v21
    v_dot2_f32_bf16 v22, v118, v18, v22
    v_add_f32_dpp v27, v27, v27 quad_perm:[2,3,0,1] row_mask:0xf bank_mask:0xf
    v_dot2_f32_bf16 v20, v111, v15, v20
    v_dot2_f32_bf16 v21, v115, v15, v21
    v_add_f32_dpp v27, v27, v27 row_half_mirror row_mask:0xf bank_mask:0xf
    v_dot2_f32_bf16 v22, v119, v19, v22
    s_mov_b32 s44, 92160
    s_waitcnt vmcnt(5)
    buffer_load_dwordx4 v[108:111], v4, s[32:35], s44 offen nt
    s_waitcnt vmcnt(5)
    buffer_load_dwordx4 v[112:115], v4, s[32:35], s44 offen offset:384 nt
    s_waitcnt vmcnt(5)
    buffer_load_dwordx4 v[116:119], v5, s[32:35], s44 offen nt
    s_waitcnt vmcnt(39)
    v_cvt_pk_bf16_f32 v31, v26, v27
    v_lshlrev_b32 v28, 16, v31
    v_and_b32 v29, 0xffff0000, v31
    v_pk_mul_f32 v[28:29], v[28:29], s[48:49]
    v_cvt_pk_bf16_f32 v31, v28, v29
    v_lshlrev_b32 v66, 16, v31
    v_and_b32 v67, 0xffff0000, v31
    v_max3_f32 v30, v30, v66, v67
    v_dot2_f32_bf16 v23, v120, v12, 0
    v_add_f32_dpp v26, v20, v20 row_ror:8 row_mask:0xf bank_mask:0xf
    v_dot2_f32_bf16 v24, v124, v12, 0
    v_dot2_f32_bf16 v25, v128, v16, 0
    v_add_f32_dpp v26, v21, v21 row_ror:8 row_mask:0xf bank_mask:0xc
    v_dot2_f32_bf16 v23, v121, v13, v23
    v_dot2_f32_bf16 v24, v125, v13, v24
    v_add_f32 v26, v26, v22
    v_dot2_f32_bf16 v25, v129, v17, v25
    v_dot2_f32_bf16 v23, v122, v14, v23
    v_add_f32_dpp v26, v26, v26 quad_perm:[1,0,3,2] row_mask:0xf bank_mask:0xf
    v_dot2_f32_bf16 v24, v126, v14, v24
    v_dot2_f32_bf16 v25, v130, v18, v25
    v_add_f32_dpp v26, v26, v26 quad_perm:[2,3,0,1] row_mask:0xf bank_mask:0xf
    v_dot2_f32_bf16 v23, v123, v15, v23
    v_dot2_f32_bf16 v24, v127, v15, v24
    v_add_f32_dpp v26, v26, v26 row_half_mirror row_mask:0xf bank_mask:0xf
    v_dot2_f32_bf16 v25, v131, v19, v25
    s_mov_b32 s44, 95232
    s_waitcnt vmcnt(5)
    buffer_load_dwordx4 v[120:123], v4, s[32:35], s44 offen nt
    s_waitcnt vmcnt(5)
    buffer_load_dwordx4 v[124:127], v4, s[32:35], s44 offen offset:384 nt
    s_waitcnt vmcnt(5)
    buffer_load_dwordx4 v[128:131], v5, s[32:35], s44 offen nt
    s_waitcnt vmcnt(39)
    v_dot2_f32_bf16 v20, v132, v12, 0
    v_add_f32_dpp v27, v23, v23 row_ror:8 row_mask:0xf bank_mask:0xf
    v_dot2_f32_bf16 v21, v136, v12, 0
    v_dot2_f32_bf16 v22, v140, v16, 0
    v_add_f32_dpp v27, v24, v24 row_ror:8 row_mask:0xf bank_mask:0xc
    v_dot2_f32_bf16 v20, v133, v13, v20
    v_dot2_f32_bf16 v21, v137, v13, v21
    v_add_f32 v27, v27, v25
    v_dot2_f32_bf16 v22, v141, v17, v22
    v_dot2_f32_bf16 v20, v134, v14, v20
    v_add_f32_dpp v27, v27, v27 quad_perm:[1,0,3,2] row_mask:0xf bank_mask:0xf
    v_dot2_f32_bf16 v21, v138, v14, v21
    v_dot2_f32_bf16 v22, v142, v18, v22
    v_add_f32_dpp v27, v27, v27 quad_perm:[2,3,0,1] row_mask:0xf bank_mask:0xf
    v_dot2_f32_bf16 v20, v135, v15, v20
    v_dot2_f32_bf16 v21, v139, v15, v21
    v_add_f32_dpp v27, v27, v27 row_half_mirror row_mask:0xf bank_mask:0xf
    v_dot2_f32_bf16 v22, v143, v19, v22
    s_mov_b32 s44, 0
    s_waitcnt vmcnt(5)
    buffer_load_dwordx4 v[132:135], v4, s[36:39], s44 offen nt
    s_waitcnt vmcnt(5)
    buffer_load_dwordx4 v[136:139], v4, s[36:39], s44 offen offset:384 nt
    s_waitcnt vmcnt(5)
    buffer_load_dwordx4 v[140:143], v5, s[36:39], s44 offen nt
    s_waitcnt vmcnt(39)
    v_cvt_pk_bf16_f32 v31, v26, v27
    v_lshlrev_b32 v28, 16, v31
    v_and_b32 v29, 0xffff0000, v31
    v_pk_mul_f32 v[28:29], v[28:29], s[48:49]
    v_cvt_pk_bf16_f32 v31, v28, v29
    v_lshlrev_b32 v68, 16, v31
    v_and_b32 v69, 0xffff0000, v31
    v_max3_f32 v30, v30, v68, v69
    v_dot2_f32_bf16 v23, v144, v12, 0
    v_add_f32_dpp v26, v20, v20 row_ror:8 row_mask:0xf bank_mask:0xf
    v_dot2_f32_bf16 v24, v148, v12, 0
    v_dot2_f32_bf16 v25, v152, v16, 0
    v_add_f32_dpp v26, v21, v21 row_ror:8 row_mask:0xf bank_mask:0xc
    v_dot2_f32_bf16 v23, v145, v13, v23
    v_dot2_f32_bf16 v24, v149, v13, v24
    v_add_f32 v26, v26, v22
    v_dot2_f32_bf16 v25, v153, v17, v25
    v_dot2_f32_bf16 v23, v146, v14, v23
    v_add_f32_dpp v26, v26, v26 quad_perm:[1,0,3,2] row_mask:0xf bank_mask:0xf
    v_dot2_f32_bf16 v24, v150, v14, v24
    v_dot2_f32_bf16 v25, v154, v18, v25
    v_add_f32_dpp v26, v26, v26 quad_perm:[2,3,0,1] row_mask:0xf bank_mask:0xf
    v_dot2_f32_bf16 v23, v147, v15, v23
    v_dot2_f32_bf16 v24, v151, v15, v24
    v_add_f32_dpp v26, v26, v26 row_half_mirror row_mask:0xf bank_mask:0xf
    v_dot2_f32_bf16 v25, v155, v19, v25
    s_mov_b32 s44, 3072
    s_waitcnt vmcnt(5)
    buffer_load_dwordx4 v[144:147], v4, s[36:39], s44 offen nt
    s_waitcnt vmcnt(5)
    buffer_load_dwordx4 v[148:151], v4, s[36:39], s44 offen offset:384 nt
    s_waitcnt vmcnt(5)
    buffer_load_dwordx4 v[152:155], v5, s[36:39], s44 offen nt
    s_waitcnt vmcnt(39)
    v_dot2_f32_bf16 v20, v156, v12, 0
    v_add_f32_dpp v27, v23, v23 row_ror:8 row_mask:0xf bank_mask:0xf
    v_dot2_f32_bf16 v21, v160, v12, 0
    v_dot2_f32_bf16 v22, v164, v16, 0
    v_add_f32_dpp v27, v24, v24 row_ror:8 row_mask:0xf bank_mask:0xc
    v_dot2_f32_bf16 v20, v157, v13, v20
    v_dot2_f32_bf16 v21, v161, v13, v21
    v_add_f32 v27, v27, v25
    v_dot2_f32_bf16 v22, v165, v17, v22
    v_dot2_f32_bf16 v20, v158, v14, v20
    v_add_f32_dpp v27, v27, v27 quad_perm:[1,0,3,2] row_mask:0xf bank_mask:0xf
    v_dot2_f32_bf16 v21, v162, v14, v21
    v_dot2_f32_bf16 v22, v166, v18, v22
    v_add_f32_dpp v27, v27, v27 quad_perm:[2,3,0,1] row_mask:0xf bank_mask:0xf
    v_dot2_f32_bf16 v20, v159, v15, v20
    v_dot2_f32_bf16 v21, v163, v15, v21
    v_add_f32_dpp v27, v27, v27 row_half_mirror row_mask:0xf bank_mask:0xf
    v_dot2_f32_bf16 v22, v167, v19, v22
    s_mov_b32 s44, 6144
    s_waitcnt vmcnt(5)
    buffer_load_dwordx4 v[156:159], v4, s[36:39], s44 offen nt
    s_waitcnt vmcnt(5)
    buffer_load_dwordx4 v[160:163], v4, s[36:39], s44 offen offset:384 nt
    s_waitcnt vmcnt(5)
    buffer_load_dwordx4 v[164:167], v5, s[36:39], s44 offen nt
    s_waitcnt vmcnt(39)
    v_cvt_pk_bf16_f32 v31, v26, v27
    v_lshlrev_b32 v28, 16, v31
    v_and_b32 v29, 0xffff0000, v31
    v_pk_mul_f32 v[28:29], v[28:29], s[48:49]
    v_cvt_pk_bf16_f32 v31, v28, v29
    v_lshlrev_b32 v70, 16, v31
    v_and_b32 v71, 0xffff0000, v31
    v_max3_f32 v30, v30, v70, v71
    v_dot2_f32_bf16 v23, v168, v12, 0
    v_add_f32_dpp v26, v20, v20 row_ror:8 row_mask:0xf bank_mask:0xf
    v_dot2_f32_bf16 v24, v172, v12, 0
    v_dot2_f32_bf16 v25, v176, v16, 0
    v_add_f32_dpp v26, v21, v21 row_ror:8 row_mask:0xf bank_mask:0xc
    v_dot2_f32_bf16 v23, v169, v13, v23
    v_dot2_f32_bf16 v24, v173, v13, v24
    v_add_f32 v26, v26, v22
    v_dot2_f32_bf16 v25, v177, v17, v25
    v_dot2_f32_bf16 v23, v170, v14, v23
    v_add_f32_dpp v26, v26, v26 quad_perm:[1,0,3,2] row_mask:0xf bank_mask:0xf
    v_dot2_f32_bf16 v24, v174, v14, v24
    v_dot2_f32_bf16 v25, v178, v18, v25
    v_add_f32_dpp v26, v26, v26 quad_perm:[2,3,0,1] row_mask:0xf bank_mask:0xf
    v_dot2_f32_bf16 v23, v171, v15, v23
    v_dot2_f32_bf16 v24, v175, v15, v24
    v_add_f32_dpp v26, v26, v26 row_half_mirror row_mask:0xf bank_mask:0xf
    v_dot2_f32_bf16 v25, v179, v19, v25
    s_mov_b32 s44, 9216
    s_waitcnt vmcnt(5)
    buffer_load_dwordx4 v[168:171], v4, s[36:39], s44 offen nt
    s_waitcnt vmcnt(5)
    buffer_load_dwordx4 v[172:175], v4, s[36:39], s44 offen offset:384 nt
    s_waitcnt vmcnt(5)
    buffer_load_dwordx4 v[176:179], v5, s[36:39], s44 offen nt
    s_waitcnt vmcnt(39)
    v_dot2_f32_bf16 v20, v180, v12, 0
    v_add_f32_dpp v27, v23, v23 row_ror:8 row_mask:0xf bank_mask:0xf
    v_dot2_f32_bf16 v21, v184, v12, 0
    v_dot2_f32_bf16 v22, v188, v16, 0
    v_add_f32_dpp v27, v24, v24 row_ror:8 row_mask:0xf bank_mask:0xc
    v_dot2_f32_bf16 v20, v181, v13, v20
    v_dot2_f32_bf16 v21, v185, v13, v21
    v_add_f32 v27, v27, v25
    v_dot2_f32_bf16 v22, v189, v17, v22
    v_dot2_f32_bf16 v20, v182, v14, v20
    v_add_f32_dpp v27, v27, v27 quad_perm:[1,0,3,2] row_mask:0xf bank_mask:0xf
    v_dot2_f32_bf16 v21, v186, v14, v21
    v_dot2_f32_bf16 v22, v190, v18, v22
    v_add_f32_dpp v27, v27, v27 quad_perm:[2,3,0,1] row_mask:0xf bank_mask:0xf
    v_dot2_f32_bf16 v20, v183, v15, v20
    v_dot2_f32_bf16 v21, v187, v15, v21
    v_add_f32_dpp v27, v27, v27 row_half_mirror row_mask:0xf bank_mask:0xf
    v_dot2_f32_bf16 v22, v191, v19, v22
    s_mov_b32 s44, 12288
    s_waitcnt vmcnt(5)
    buffer_load_dwordx4 v[180:183], v4, s[36:39], s44 offen nt
    s_waitcnt vmcnt(5)
    buffer_load_dwordx4 v[184:187], v4, s[36:39], s44 offen offset:384 nt
    s_waitcnt vmcnt(5)
    buffer_load_dwordx4 v[188:191], v5, s[36:39], s44 offen nt
    s_waitcnt vmcnt(39)
    v_cvt_pk_bf16_f32 v31, v26, v27
    v_lshlrev_b32 v28, 16, v31
    v_and_b32 v29, 0xffff0000, v31
    v_pk_mul_f32 v[28:29], v[28:29], s[48:49]
    v_cvt_pk_bf16_f32 v31, v28, v29
    v_lshlrev_b32 v72, 16, v31
    v_and_b32 v73, 0xffff0000, v31
    v_max3_f32 v30, v30, v72, v73
    v_dot2_f32_bf16 v23, v192, v12, 0
    v_add_f32_dpp v26, v20, v20 row_ror:8 row_mask:0xf bank_mask:0xf
    v_dot2_f32_bf16 v24, v196, v12, 0
    v_dot2_f32_bf16 v25, v200, v16, 0
    v_add_f32_dpp v26, v21, v21 row_ror:8 row_mask:0xf bank_mask:0xc
    v_dot2_f32_bf16 v23, v193, v13, v23
    v_dot2_f32_bf16 v24, v197, v13, v24
    v_add_f32 v26, v26, v22
    v_dot2_f32_bf16 v25, v201, v17, v25
    v_dot2_f32_bf16 v23, v194, v14, v23
    v_add_f32_dpp v26, v26, v26 quad_perm:[1,0,3,2] row_mask:0xf bank_mask:0xf
    v_dot2_f32_bf16 v24, v198, v14, v24
    v_dot2_f32_bf16 v25, v202, v18, v25
    v_add_f32_dpp v26, v26, v26 quad_perm:[2,3,0,1] row_mask:0xf bank_mask:0xf
    v_dot2_f32_bf16 v23, v195, v15, v23
    v_dot2_f32_bf16 v24, v199, v15, v24
    v_add_f32_dpp v26, v26, v26 row_half_mirror row_mask:0xf bank_mask:0xf
    v_dot2_f32_bf16 v25, v203, v19, v25
    s_mov_b32 s44, 15360
    s_waitcnt vmcnt(5)
    buffer_load_dwordx4 v[192:195], v4, s[36:39], s44 offen nt
    s_waitcnt vmcnt(5)
    buffer_load_dwordx4 v[196:199], v4, s[36:39], s44 offen offset:384 nt
    s_waitcnt vmcnt(5)
    buffer_load_dwordx4 v[200:203], v5, s[36:39], s44 offen nt
    s_waitcnt vmcnt(39)
    v_dot2_f32_bf16 v20, v204, v12, 0
    v_add_f32_dpp v27, v23, v23 row_ror:8 row_mask:0xf bank_mask:0xf
    v_dot2_f32_bf16 v21, v208, v12, 0
    v_dot2_f32_bf16 v22, v212, v16, 0
    v_add_f32_dpp v27, v24, v24 row_ror:8 row_mask:0xf bank_mask:0xc
    v_dot2_f32_bf16 v20, v205, v13, v20
    v_dot2_f32_bf16 v21, v209, v13, v21
    v_add_f32 v27, v27, v25
    v_dot2_f32_bf16 v22, v213, v17, v22
    v_dot2_f32_bf16 v20, v206, v14, v20
    v_add_f32_dpp v27, v27, v27 quad_perm:[1,0,3,2] row_mask:0xf bank_mask:0xf
    v_dot2_f32_bf16 v21, v210, v14, v21
    v_dot2_f32_bf16 v22, v214, v18, v22
    v_add_f32_dpp v27, v27, v27 quad_perm:[2,3,0,1] row_mask:0xf bank_mask:0xf
    v_dot2_f32_bf16 v20, v207, v15, v20
    v_dot2_f32_bf16 v21, v211, v15, v21
    v_add_f32_dpp v27, v27, v27 row_half_mirror row_mask:0xf bank_mask:0xf
    v_dot2_f32_bf16 v22, v215, v19, v22
    s_mov_b32 s44, 18432
    s_waitcnt vmcnt(5)
    buffer_load_dwordx4 v[204:207], v4, s[36:39], s44 offen nt
    s_waitcnt vmcnt(5)
    buffer_load_dwordx4 v[208:211], v4, s[36:39], s44 offen offset:384 nt
    s_waitcnt vmcnt(5)
    buffer_load_dwordx4 v[212:215], v5, s[36:39], s44 offen nt
    s_waitcnt vmcnt(39)
    v_cvt_pk_bf16_f32 v31, v26, v27
    v_lshlrev_b32 v28, 16, v31
    v_and_b32 v29, 0xffff0000, v31
    v_pk_mul_f32 v[28:29], v[28:29], s[48:49]
    v_cvt_pk_bf16_f32 v31, v28, v29
    v_lshlrev_b32 v74, 16, v31
    v_and_b32 v75, 0xffff0000, v31
    v_max3_f32 v30, v30, v74, v75
    v_dot2_f32_bf16 v23, v216, v12, 0
    v_add_f32_dpp v26, v20, v20 row_ror:8 row_mask:0xf bank_mask:0xf
    v_dot2_f32_bf16 v24, v220, v12, 0
    v_dot2_f32_bf16 v25, v224, v16, 0
    v_add_f32_dpp v26, v21, v21 row_ror:8 row_mask:0xf bank_mask:0xc
    v_dot2_f32_bf16 v23, v217, v13, v23
    v_dot2_f32_bf16 v24, v221, v13, v24
    v_add_f32 v26, v26, v22
    v_dot2_f32_bf16 v25, v225, v17, v25
    v_dot2_f32_bf16 v23, v218, v14, v23
    v_add_f32_dpp v26, v26, v26 quad_perm:[1,0,3,2] row_mask:0xf bank_mask:0xf
    v_dot2_f32_bf16 v24, v222, v14, v24
    v_dot2_f32_bf16 v25, v226, v18, v25
    v_add_f32_dpp v26, v26, v26 quad_perm:[2,3,0,1] row_mask:0xf bank_mask:0xf
    v_dot2_f32_bf16 v23, v219, v15, v23
    v_dot2_f32_bf16 v24, v223, v15, v24
    v_add_f32_dpp v26, v26, v26 row_half_mirror row_mask:0xf bank_mask:0xf
    v_dot2_f32_bf16 v25, v227, v19, v25
    s_mov_b32 s44, 21504
    s_waitcnt vmcnt(5)
    buffer_load_dwordx4 v[216:219], v4, s[36:39], s44 offen nt
    s_waitcnt vmcnt(5)
    buffer_load_dwordx4 v[220:223], v4, s[36:39], s44 offen offset:384 nt
    s_waitcnt vmcnt(5)
    buffer_load_dwordx4 v[224:227], v5, s[36:39], s44 offen nt
    s_waitcnt vmcnt(39)
    v_dot2_f32_bf16 v20, v228, v12, 0
    v_add_f32_dpp v27, v23, v23 row_ror:8 row_mask:0xf bank_mask:0xf
    v_dot2_f32_bf16 v21, v232, v12, 0
    v_dot2_f32_bf16 v22, v236, v16, 0
    v_add_f32_dpp v27, v24, v24 row_ror:8 row_mask:0xf bank_mask:0xc
    v_dot2_f32_bf16 v20, v229, v13, v20
    v_dot2_f32_bf16 v21, v233, v13, v21
    v_add_f32 v27, v27, v25
    v_dot2_f32_bf16 v22, v237, v17, v22
    v_dot2_f32_bf16 v20, v230, v14, v20
    v_add_f32_dpp v27, v27, v27 quad_perm:[1,0,3,2] row_mask:0xf bank_mask:0xf
    v_dot2_f32_bf16 v21, v234, v14, v21
    v_dot2_f32_bf16 v22, v238, v18, v22
    v_add_f32_dpp v27, v27, v27 quad_perm:[2,3,0,1] row_mask:0xf bank_mask:0xf
    v_dot2_f32_bf16 v20, v231, v15, v20
    v_dot2_f32_bf16 v21, v235, v15, v21
    v_add_f32_dpp v27, v27, v27 row_half_mirror row_mask:0xf bank_mask:0xf
    v_dot2_f32_bf16 v22, v239, v19, v22
    s_mov_b32 s44, 24576
    s_waitcnt vmcnt(5)
    buffer_load_dwordx4 v[228:231], v4, s[36:39], s44 offen nt
    s_waitcnt vmcnt(5)
    buffer_load_dwordx4 v[232:235], v4, s[36:39], s44 offen offset:384 nt
    s_waitcnt vmcnt(5)
    buffer_load_dwordx4 v[236:239], v5, s[36:39], s44 offen nt
    s_waitcnt vmcnt(39)
    v_cvt_pk_bf16_f32 v31, v26, v27
    v_lshlrev_b32 v28, 16, v31
    v_and_b32 v29, 0xffff0000, v31
    v_pk_mul_f32 v[28:29], v[28:29], s[48:49]
    v_cvt_pk_bf16_f32 v31, v28, v29
    v_lshlrev_b32 v76, 16, v31
    v_and_b32 v77, 0xffff0000, v31
    v_max3_f32 v30, v30, v76, v77
    v_dot2_f32_bf16 v23, v240, v12, 0
    v_add_f32_dpp v26, v20, v20 row_ror:8 row_mask:0xf bank_mask:0xf
    v_dot2_f32_bf16 v24, v244, v12, 0
    v_dot2_f32_bf16 v25, v248, v16, 0
    v_add_f32_dpp v26, v21, v21 row_ror:8 row_mask:0xf bank_mask:0xc
    v_dot2_f32_bf16 v23, v241, v13, v23
    v_dot2_f32_bf16 v24, v245, v13, v24
    v_add_f32 v26, v26, v22
    v_dot2_f32_bf16 v25, v249, v17, v25
    v_dot2_f32_bf16 v23, v242, v14, v23
    v_add_f32_dpp v26, v26, v26 quad_perm:[1,0,3,2] row_mask:0xf bank_mask:0xf
    v_dot2_f32_bf16 v24, v246, v14, v24
    v_dot2_f32_bf16 v25, v250, v18, v25
    v_add_f32_dpp v26, v26, v26 quad_perm:[2,3,0,1] row_mask:0xf bank_mask:0xf
    v_dot2_f32_bf16 v23, v243, v15, v23
    v_dot2_f32_bf16 v24, v247, v15, v24
    v_add_f32_dpp v26, v26, v26 row_half_mirror row_mask:0xf bank_mask:0xf
    v_dot2_f32_bf16 v25, v251, v19, v25
    s_mov_b32 s44, 27648
    s_waitcnt vmcnt(5)
    buffer_load_dwordx4 v[240:243], v4, s[36:39], s44 offen nt
    s_waitcnt vmcnt(5)
    buffer_load_dwordx4 v[244:247], v4, s[36:39], s44 offen offset:384 nt
    s_waitcnt vmcnt(5)
    buffer_load_dwordx4 v[248:251], v5, s[36:39], s44 offen nt
    s_waitcnt vmcnt(39)
    v_dot2_f32_bf16 v20, v84, v12, 0
    v_add_f32_dpp v27, v23, v23 row_ror:8 row_mask:0xf bank_mask:0xf
    v_dot2_f32_bf16 v21, v88, v12, 0
    v_dot2_f32_bf16 v22, v92, v16, 0
    v_add_f32_dpp v27, v24, v24 row_ror:8 row_mask:0xf bank_mask:0xc
    v_dot2_f32_bf16 v20, v85, v13, v20
    v_dot2_f32_bf16 v21, v89, v13, v21
    v_add_f32 v27, v27, v25
    v_dot2_f32_bf16 v22, v93, v17, v22
    v_dot2_f32_bf16 v20, v86, v14, v20
    v_add_f32_dpp v27, v27, v27 quad_perm:[1,0,3,2] row_mask:0xf bank_mask:0xf
    v_dot2_f32_bf16 v21, v90, v14, v21
    v_dot2_f32_bf16 v22, v94, v18, v22
    v_add_f32_dpp v27, v27, v27 quad_perm:[2,3,0,1] row_mask:0xf bank_mask:0xf
    v_dot2_f32_bf16 v20, v87, v15, v20
    v_dot2_f32_bf16 v21, v91, v15, v21
    v_add_f32_dpp v27, v27, v27 row_half_mirror row_mask:0xf bank_mask:0xf
    v_dot2_f32_bf16 v22, v95, v19, v22
    s_mov_b32 s44, 30720
    s_waitcnt vmcnt(5)
    buffer_load_dwordx4 v[84:87], v4, s[36:39], s44 offen nt
    s_waitcnt vmcnt(5)
    buffer_load_dwordx4 v[88:91], v4, s[36:39], s44 offen offset:384 nt
    s_waitcnt vmcnt(5)
    buffer_load_dwordx4 v[92:95], v5, s[36:39], s44 offen nt
    s_waitcnt vmcnt(39)
    v_cvt_pk_bf16_f32 v31, v26, v27
    v_lshlrev_b32 v28, 16, v31
    v_and_b32 v29, 0xffff0000, v31
    v_pk_mul_f32 v[28:29], v[28:29], s[48:49]
    v_cvt_pk_bf16_f32 v31, v28, v29
    v_lshlrev_b32 v78, 16, v31
    v_and_b32 v79, 0xffff0000, v31
    v_max3_f32 v30, v30, v78, v79
    v_dot2_f32_bf16 v23, v96, v12, 0
    v_add_f32_dpp v26, v20, v20 row_ror:8 row_mask:0xf bank_mask:0xf
    v_dot2_f32_bf16 v24, v100, v12, 0
    v_dot2_f32_bf16 v25, v104, v16, 0
    v_add_f32_dpp v26, v21, v21 row_ror:8 row_mask:0xf bank_mask:0xc
    v_dot2_f32_bf16 v23, v97, v13, v23
    v_dot2_f32_bf16 v24, v101, v13, v24
    v_add_f32 v26, v26, v22
    v_dot2_f32_bf16 v25, v105, v17, v25
    v_dot2_f32_bf16 v23, v98, v14, v23
    v_add_f32_dpp v26, v26, v26 quad_perm:[1,0,3,2] row_mask:0xf bank_mask:0xf
    v_dot2_f32_bf16 v24, v102, v14, v24
    v_dot2_f32_bf16 v25, v106, v18, v25
    v_add_f32_dpp v26, v26, v26 quad_perm:[2,3,0,1] row_mask:0xf bank_mask:0xf
    v_dot2_f32_bf16 v23, v99, v15, v23
    v_dot2_f32_bf16 v24, v103, v15, v24
    v_add_f32_dpp v26, v26, v26 row_half_mirror row_mask:0xf bank_mask:0xf
    v_dot2_f32_bf16 v25, v107, v19, v25
    s_mov_b32 s44, 33792
    s_waitcnt vmcnt(5)
    buffer_load_dwordx4 v[96:99], v4, s[36:39], s44 offen nt
    s_waitcnt vmcnt(5)
    buffer_load_dwordx4 v[100:103], v4, s[36:39], s44 offen offset:384 nt
    s_waitcnt vmcnt(5)
    buffer_load_dwordx4 v[104:107], v5, s[36:39], s44 offen nt
    s_waitcnt vmcnt(39)
    v_dot2_f32_bf16 v20, v108, v12, 0
    v_add_f32_dpp v27, v23, v23 row_ror:8 row_mask:0xf bank_mask:0xf
    v_dot2_f32_bf16 v21, v112, v12, 0
    v_dot2_f32_bf16 v22, v116, v16, 0
    v_add_f32_dpp v27, v24, v24 row_ror:8 row_mask:0xf bank_mask:0xc
    v_dot2_f32_bf16 v20, v109, v13, v20
    v_dot2_f32_bf16 v21, v113, v13, v21
    v_add_f32 v27, v27, v25
    v_dot2_f32_bf16 v22, v117, v17, v22
    v_dot2_f32_bf16 v20, v110, v14, v20
    v_add_f32_dpp v27, v27, v27 quad_perm:[1,0,3,2] row_mask:0xf bank_mask:0xf
    v_dot2_f32_bf16 v21, v114, v14, v21
    v_dot2_f32_bf16 v22, v118, v18, v22
    v_add_f32_dpp v27, v27, v27 quad_perm:[2,3,0,1] row_mask:0xf bank_mask:0xf
    v_dot2_f32_bf16 v20, v111, v15, v20
    v_dot2_f32_bf16 v21, v115, v15, v21
    v_add_f32_dpp v27, v27, v27 row_half_mirror row_mask:0xf bank_mask:0xf
    v_dot2_f32_bf16 v22, v119, v19, v22
    s_mov_b32 s44, 36864
    s_waitcnt vmcnt(5)
    buffer_load_dwordx4 v[108:111], v4, s[36:39], s44 offen nt
    s_waitcnt vmcnt(5)
    buffer_load_dwordx4 v[112:115], v4, s[36:39], s44 offen offset:384 nt
    s_waitcnt vmcnt(5)
    buffer_load_dwordx4 v[116:119], v5, s[36:39], s44 offen nt
    s_waitcnt vmcnt(39)
    v_cvt_pk_bf16_f32 v31, v26, v27
    v_lshlrev_b32 v28, 16, v31
    v_and_b32 v29, 0xffff0000, v31
    v_pk_mul_f32 v[28:29], v[28:29], s[48:49]
    v_cvt_pk_bf16_f32 v31, v28, v29
    v_lshlrev_b32 v80, 16, v31
    v_and_b32 v81, 0xffff0000, v31
    v_max3_f32 v30, v30, v80, v81
    v_dot2_f32_bf16 v23, v120, v12, 0
    v_add_f32_dpp v26, v20, v20 row_ror:8 row_mask:0xf bank_mask:0xf
    v_dot2_f32_bf16 v24, v124, v12, 0
    v_dot2_f32_bf16 v25, v128, v16, 0
    v_add_f32_dpp v26, v21, v21 row_ror:8 row_mask:0xf bank_mask:0xc
    v_dot2_f32_bf16 v23, v121, v13, v23
    v_dot2_f32_bf16 v24, v125, v13, v24
    v_add_f32 v26, v26, v22
    v_dot2_f32_bf16 v25, v129, v17, v25
    v_dot2_f32_bf16 v23, v122, v14, v23
    v_add_f32_dpp v26, v26, v26 quad_perm:[1,0,3,2] row_mask:0xf bank_mask:0xf
    v_dot2_f32_bf16 v24, v126, v14, v24
    v_dot2_f32_bf16 v25, v130, v18, v25
    v_add_f32_dpp v26, v26, v26 quad_perm:[2,3,0,1] row_mask:0xf bank_mask:0xf
    v_dot2_f32_bf16 v23, v123, v15, v23
    v_dot2_f32_bf16 v24, v127, v15, v24
    v_add_f32_dpp v26, v26, v26 row_half_mirror row_mask:0xf bank_mask:0xf
    v_dot2_f32_bf16 v25, v131, v19, v25
    s_mov_b32 s44, 39936
    s_waitcnt vmcnt(5)
    buffer_load_dwordx4 v[120:123], v4, s[36:39], s44 offen nt
    s_waitcnt vmcnt(5)
    buffer_load_dwordx4 v[124:127], v4, s[36:39], s44 offen offset:384 nt
    s_waitcnt vmcnt(5)
    buffer_load_dwordx4 v[128:131], v5, s[36:39], s44 offen nt
    v_add_f32_dpp v27, v23, v23 row_ror:8 row_mask:0xf bank_mask:0xf
    s_nop 1
    v_add_f32_dpp v27, v24, v24 row_ror:8 row_mask:0xf bank_mask:0xc
    v_add_f32 v27, v27, v25
    s_nop 1
    v_add_f32_dpp v27, v27, v27 quad_perm:[1,0,3,2] row_mask:0xf bank_mask:0xf
    s_nop 1
    v_add_f32_dpp v27, v27, v27 quad_perm:[2,3,0,1] row_mask:0xf bank_mask:0xf
    s_nop 1
    v_add_f32_dpp v27, v27, v27 row_half_mirror row_mask:0xf bank_mask:0xf
    v_cvt_pk_bf16_f32 v31, v26, v27
    v_lshlrev_b32 v28, 16, v31
    v_and_b32 v29, 0xffff0000, v31
    v_pk_mul_f32 v[28:29], v[28:29], s[48:49]
    v_cvt_pk_bf16_f32 v31, v28, v29
    v_lshlrev_b32 v82, 16, v31
    v_and_b32 v83, 0xffff0000, v31
    v_max3_f32 v30, v30, v82, v83
    s_nop 1
    v_max_f32_dpp v30, v30, v30 row_ror:8 row_mask:0xf bank_mask:0xf
    v_mov_b32 v31, v30
    s_nop 1
    v_permlane16_swap_b32 v30, v31
    v_max_f32 v30, v30, v31
    v_mov_b32 v31, v30
    s_nop 1
    v_permlane32_swap_b32 v30, v31
    v_max_f32 v30, v30, v31
    s_lshl_b32 s57, s59, 2
    v_mov_b32 v31, s57
    s_mov_b64 exec, 1
    ds_write_b32 v31, v30 offset:896
    s_mov_b64 exec, -1
    v_mov_b32 v31, 0
    s_waitcnt lgkmcnt(0)
    s_barrier
    ds_read_b128 v[20:23], v31 offset:896
    s_waitcnt lgkmcnt(0)
    v_max3_f32 v20, v20, v21, v22
    v_max_f32 v30, v20, v23
    v_sub_f32 v28, 0, v30
    v_pk_add_f32 v[52:53], v[52:53], v[28:29] op_sel_hi:[1,0]
    v_pk_add_f32 v[54:55], v[54:55], v[28:29] op_sel_hi:[1,0]
    v_pk_add_f32 v[56:57], v[56:57], v[28:29] op_sel_hi:[1,0]
    v_pk_add_f32 v[58:59], v[58:59], v[28:29] op_sel_hi:[1,0]
    v_pk_add_f32 v[60:61], v[60:61], v[28:29] op_sel_hi:[1,0]
    v_pk_add_f32 v[62:63], v[62:63], v[28:29] op_sel_hi:[1,0]
    v_pk_add_f32 v[64:65], v[64:65], v[28:29] op_sel_hi:[1,0]
    v_pk_add_f32 v[66:67], v[66:67], v[28:29] op_sel_hi:[1,0]
    v_pk_add_f32 v[68:69], v[68:69], v[28:29] op_sel_hi:[1,0]
    v_pk_add_f32 v[70:71], v[70:71], v[28:29] op_sel_hi:[1,0]
    v_pk_add_f32 v[72:73], v[72:73], v[28:29] op_sel_hi:[1,0]
    v_pk_add_f32 v[74:75], v[74:75], v[28:29] op_sel_hi:[1,0]
    v_pk_add_f32 v[76:77], v[76:77], v[28:29] op_sel_hi:[1,0]
    v_pk_add_f32 v[78:79], v[78:79], v[28:29] op_sel_hi:[1,0]
    v_pk_add_f32 v[80:81], v[80:81], v[28:29] op_sel_hi:[1,0]
    v_pk_add_f32 v[82:83], v[82:83], v[28:29] op_sel_hi:[1,0]
    v_pk_mul_f32 v[52:53], v[52:53], s[50:51]
    v_pk_mul_f32 v[54:55], v[54:55], s[50:51]
    v_pk_mul_f32 v[56:57], v[56:57], s[50:51]
    v_pk_mul_f32 v[58:59], v[58:59], s[50:51]
    v_pk_mul_f32 v[60:61], v[60:61], s[50:51]
    v_pk_mul_f32 v[62:63], v[62:63], s[50:51]
    v_pk_mul_f32 v[64:65], v[64:65], s[50:51]
    v_pk_mul_f32 v[66:67], v[66:67], s[50:51]
    v_pk_mul_f32 v[68:69], v[68:69], s[50:51]
    v_pk_mul_f32 v[70:71], v[70:71], s[50:51]
    v_pk_mul_f32 v[72:73], v[72:73], s[50:51]
    v_pk_mul_f32 v[74:75], v[74:75], s[50:51]
    v_pk_mul_f32 v[76:77], v[76:77], s[50:51]
    v_pk_mul_f32 v[78:79], v[78:79], s[50:51]
    v_pk_mul_f32 v[80:81], v[80:81], s[50:51]
    v_pk_mul_f32 v[82:83], v[82:83], s[50:51]
    v_exp_f32 v52, v52
    v_exp_f32 v53, v53
    v_exp_f32 v54, v54
    v_exp_f32 v55, v55
    v_exp_f32 v56, v56
    v_exp_f32 v57, v57
    v_exp_f32 v58, v58
    v_exp_f32 v59, v59
    v_exp_f32 v60, v60
    v_exp_f32 v61, v61
    v_exp_f32 v62, v62
    v_exp_f32 v63, v63
    v_exp_f32 v64, v64
    v_exp_f32 v65, v65
    v_exp_f32 v66, v66
    v_exp_f32 v67, v67
    v_exp_f32 v68, v68
    v_exp_f32 v69, v69
    v_exp_f32 v70, v70
    v_exp_f32 v71, v71
    v_exp_f32 v72, v72
    v_exp_f32 v73, v73
    v_exp_f32 v74, v74
    v_exp_f32 v75, v75
    v_exp_f32 v76, v76
    v_exp_f32 v77, v77
    v_exp_f32 v78, v78
    v_exp_f32 v79, v79
    v_exp_f32 v80, v80
    v_exp_f32 v81, v81
    v_exp_f32 v82, v82
    v_exp_f32 v83, v83
    v_pk_add_f32 v[26:27], v[52:53], v[54:55]
    v_pk_add_f32 v[24:25], v[56:57], v[58:59]
    v_pk_add_f32 v[26:27], v[26:27], v[60:61]
    v_pk_add_f32 v[24:25], v[24:25], v[62:63]
    v_pk_add_f32 v[26:27], v[26:27], v[64:65]
    v_pk_add_f32 v[24:25], v[24:25], v[66:67]
    v_pk_add_f32 v[26:27], v[26:27], v[68:69]
    v_pk_add_f32 v[24:25], v[24:25], v[70:71]
    v_pk_add_f32 v[26:27], v[26:27], v[72:73]
    v_pk_add_f32 v[24:25], v[24:25], v[74:75]
    v_pk_add_f32 v[26:27], v[26:27], v[76:77]
    v_pk_add_f32 v[24:25], v[24:25], v[78:79]
    v_pk_add_f32 v[26:27], v[26:27], v[80:81]
    v_pk_add_f32 v[24:25], v[24:25], v[82:83]
    v_cvt_pk_bf16_f32 v52, v52, v52
    v_cvt_pk_bf16_f32 v53, v53, v53
    v_cvt_pk_bf16_f32 v54, v54, v54
    v_cvt_pk_bf16_f32 v55, v55, v55
    v_cvt_pk_bf16_f32 v56, v56, v56
    v_cvt_pk_bf16_f32 v57, v57, v57
    v_cvt_pk_bf16_f32 v58, v58, v58
    v_cvt_pk_bf16_f32 v59, v59, v59
    v_cvt_pk_bf16_f32 v60, v60, v60
    v_cvt_pk_bf16_f32 v61, v61, v61
    v_cvt_pk_bf16_f32 v62, v62, v62
    v_cvt_pk_bf16_f32 v63, v63, v63
    v_cvt_pk_bf16_f32 v64, v64, v64
    v_cvt_pk_bf16_f32 v65, v65, v65
    v_cvt_pk_bf16_f32 v66, v66, v66
    v_cvt_pk_bf16_f32 v67, v67, v67
    v_cvt_pk_bf16_f32 v68, v68, v68
    v_cvt_pk_bf16_f32 v69, v69, v69
    v_cvt_pk_bf16_f32 v70, v70, v70
    v_cvt_pk_bf16_f32 v71, v71, v71
    v_cvt_pk_bf16_f32 v72, v72, v72
    v_cvt_pk_bf16_f32 v73, v73, v73
    v_cvt_pk_bf16_f32 v74, v74, v74
    v_cvt_pk_bf16_f32 v75, v75, v75
    v_cvt_pk_bf16_f32 v76, v76, v76
    v_cvt_pk_bf16_f32 v77, v77, v77
    v_cvt_pk_bf16_f32 v78, v78, v78
    v_cvt_pk_bf16_f32 v79, v79, v79
    v_cvt_pk_bf16_f32 v80, v80, v80
    v_cvt_pk_bf16_f32 v81, v81, v81
    v_cvt_pk_bf16_f32 v82, v82, v82
    v_cvt_pk_bf16_f32 v83, v83, v83
    v_pk_add_f32 v[26:27], v[26:27], v[24:25]
    v_add_f32 v29, v26, v27
    s_nop 1
    v_add_f32_dpp v29, v29, v29 row_ror:8 row_mask:0xf bank_mask:0xf
    v_mov_b32 v31, v29
    s_nop 1
    v_permlane16_swap_b32 v29, v31
    v_add_f32 v29, v29, v31
    v_mov_b32 v31, v29
    s_nop 1
    v_permlane32_swap_b32 v29, v31
    v_add_f32 v29, v29, v31
    v_lshrrev_b32 v10, 1, v2
    s_lshl_b32 s57, s59, 1
    v_add_u32 v10, s57, v10
    v_mul_u32_u24 v10, 784, v10
    v_and_b32 v11, 1, v2
    v_lshlrev_b32 v11, 4, v11
    v_add_u32 v12, v10, v11
    v_lshl_add_u32 v13, v3, 5, v12
    v_and_b32 v11, 7, v3
    v_lshl_add_u32 v14, v11, 5, v12
    s_mov_b32 s48, 0
    s_mov_b32 s49, -1
    s_cmp_eq_u32 s59, 0
    s_cselect_b32 s50, 1, 0
    s_mov_b32 s51, 0
    v_mov_b32 v18, 0
    v_mov_b32 v19, 0
    v_cndmask_b32 v16, v19, v30, s[50:51]
    v_cndmask_b32 v17, v29, v18, s[48:49]
    s_mov_b32 exec_lo, 1
    s_mov_b32 exec_hi, 1
    ds_write_b128 v10, v[16:19] offset:1792
    s_mov_b64 exec, -1
    v_and_b32 v10, 3, v3
    v_mul_u32_u24 v10, 3, v10
    v_lshrrev_b32 v11, 2, v3
    v_add_u32 v10, v10, v11
    v_mov_b32 v10, v3
    v_mul_u32_u24 v11, 12, v2
    v_add_u32 v10, v10, v11
    v_cmp_le_u32 vcc, 12, v3
    v_mov_b32 v11, 48
    s_nop 0
    v_cndmask_b32 v10, v10, v11, vcc
    v_lshlrev_b32 v15, 4, v10
    v_lshlrev_b32 v12, 4, v0
    s_lshl_b32 s61, s63, 10
    s_add_u32 s61, s61, 851968
    v_mov_b32 v20, 0
    ds_read_b32 v20, v20 offset:912
    s_waitcnt lgkmcnt(0)
    v_readfirstlane_b32 s62, v20
    s_waitcnt lgkmcnt(0)
    s_mul_i32 s7, s6, 0x9E3779B1
    s_add_u32 s7, s7, 0x7F4A7C15
    s_add_u32 s53, s6, 0x55
    s_and_b32 s53, s53, 0x7F
    s_or_b32 s53, s53, 0x80
    v_mov_b32 v11, s53
    s_mov_b32 s57, 0xffffff00
    v_cmp_le_u32 vcc, 12, v3
    v_mov_b32 v24, 0x8000
    v_mov_b32 v25, 0xffff0000
    v_mov_b32 v26, 0xffffff00
    v_cndmask_b32 v24, v24, 0, vcc
    v_cndmask_b32 v25, v25, v26, vcc
    v_and_b32 v32, v52, v6
    v_and_b32 v33, v52, v7
    v_and_b32 v34, v52, v8
    v_and_b32 v35, v52, v9
    s_waitcnt vmcnt(39)
    s_nop 0
    v_mfma_f32_16x16x32_bf16 v[40:43], v[32:35], v[132:135], 0
    v_mfma_f32_16x16x32_bf16 v[44:47], v[32:35], v[136:139], 0
    v_mfma_f32_16x16x32_bf16 v[48:51], v[32:35], v[140:143], 0
    s_mov_b32 s44, 43008
    s_waitcnt vmcnt(11)
    buffer_load_dwordx4 v[132:135], v4, s[36:39], s44 offen nt
    s_waitcnt vmcnt(11)
    buffer_load_dwordx4 v[136:139], v4, s[36:39], s44 offen offset:384 nt
    s_waitcnt vmcnt(11)
    buffer_load_dwordx4 v[140:143], v5, s[36:39], s44 offen nt
    v_and_b32 v36, v53, v6
    v_and_b32 v37, v53, v7
    v_and_b32 v38, v53, v8
    v_and_b32 v39, v53, v9
    s_waitcnt vmcnt(39)
    s_nop 0
    v_mfma_f32_16x16x32_bf16 v[40:43], v[36:39], v[144:147], v[40:43]
    v_mfma_f32_16x16x32_bf16 v[44:47], v[36:39], v[148:151], v[44:47]
    v_mfma_f32_16x16x32_bf16 v[48:51], v[36:39], v[152:155], v[48:51]
    s_mov_b32 s44, 46080
    s_waitcnt vmcnt(11)
    buffer_load_dwordx4 v[144:147], v4, s[36:39], s44 offen nt
    s_waitcnt vmcnt(11)
    buffer_load_dwordx4 v[148:151], v4, s[36:39], s44 offen offset:384 nt
    s_waitcnt vmcnt(11)
    buffer_load_dwordx4 v[152:155], v5, s[36:39], s44 offen nt
    v_and_b32 v32, v54, v6
    v_and_b32 v33, v54, v7
    v_and_b32 v34, v54, v8
    v_and_b32 v35, v54, v9
    s_waitcnt vmcnt(39)
    s_nop 0
    v_mfma_f32_16x16x32_bf16 v[40:43], v[32:35], v[156:159], v[40:43]
    v_mfma_f32_16x16x32_bf16 v[44:47], v[32:35], v[160:163], v[44:47]
    v_mfma_f32_16x16x32_bf16 v[48:51], v[32:35], v[164:167], v[48:51]
    s_mov_b32 s44, 49152
    s_waitcnt vmcnt(11)
    buffer_load_dwordx4 v[156:159], v4, s[36:39], s44 offen nt
    s_waitcnt vmcnt(11)
    buffer_load_dwordx4 v[160:163], v4, s[36:39], s44 offen offset:384 nt
    s_waitcnt vmcnt(11)
    buffer_load_dwordx4 v[164:167], v5, s[36:39], s44 offen nt
    v_and_b32 v36, v55, v6
    v_and_b32 v37, v55, v7
    v_and_b32 v38, v55, v8
    v_and_b32 v39, v55, v9
    s_waitcnt vmcnt(39)
    s_nop 0
    v_mfma_f32_16x16x32_bf16 v[40:43], v[36:39], v[168:171], v[40:43]
    v_mfma_f32_16x16x32_bf16 v[44:47], v[36:39], v[172:175], v[44:47]
    v_mfma_f32_16x16x32_bf16 v[48:51], v[36:39], v[176:179], v[48:51]
    s_mov_b32 s44, 52224
    s_waitcnt vmcnt(11)
    buffer_load_dwordx4 v[168:171], v4, s[36:39], s44 offen nt
    s_waitcnt vmcnt(11)
    buffer_load_dwordx4 v[172:175], v4, s[36:39], s44 offen offset:384 nt
    s_waitcnt vmcnt(11)
    buffer_load_dwordx4 v[176:179], v5, s[36:39], s44 offen nt
    v_and_b32 v32, v56, v6
    v_and_b32 v33, v56, v7
    v_and_b32 v34, v56, v8
    v_and_b32 v35, v56, v9
    s_waitcnt vmcnt(39)
    s_nop 0
    v_mfma_f32_16x16x32_bf16 v[40:43], v[32:35], v[180:183], v[40:43]
    v_mfma_f32_16x16x32_bf16 v[44:47], v[32:35], v[184:187], v[44:47]
    v_mfma_f32_16x16x32_bf16 v[48:51], v[32:35], v[188:191], v[48:51]
    s_mov_b32 s44, 55296
    s_waitcnt vmcnt(11)
    buffer_load_dwordx4 v[180:183], v4, s[36:39], s44 offen nt
    s_waitcnt vmcnt(11)
    buffer_load_dwordx4 v[184:187], v4, s[36:39], s44 offen offset:384 nt
    s_waitcnt vmcnt(11)
    buffer_load_dwordx4 v[188:191], v5, s[36:39], s44 offen nt
    v_and_b32 v36, v57, v6
    v_and_b32 v37, v57, v7
    v_and_b32 v38, v57, v8
    v_and_b32 v39, v57, v9
    s_waitcnt vmcnt(39)
    s_nop 0
    v_mfma_f32_16x16x32_bf16 v[40:43], v[36:39], v[192:195], v[40:43]
    v_mfma_f32_16x16x32_bf16 v[44:47], v[36:39], v[196:199], v[44:47]
    v_mfma_f32_16x16x32_bf16 v[48:51], v[36:39], v[200:203], v[48:51]
    s_mov_b32 s44, 58368
    s_waitcnt vmcnt(11)
    buffer_load_dwordx4 v[192:195], v4, s[36:39], s44 offen nt
    s_waitcnt vmcnt(11)
    buffer_load_dwordx4 v[196:199], v4, s[36:39], s44 offen offset:384 nt
    s_waitcnt vmcnt(11)
    buffer_load_dwordx4 v[200:203], v5, s[36:39], s44 offen nt
    v_and_b32 v32, v58, v6
    v_and_b32 v33, v58, v7
    v_and_b32 v34, v58, v8
    v_and_b32 v35, v58, v9
    s_waitcnt vmcnt(39)
    s_nop 0
    v_mfma_f32_16x16x32_bf16 v[40:43], v[32:35], v[204:207], v[40:43]
    v_mfma_f32_16x16x32_bf16 v[44:47], v[32:35], v[208:211], v[44:47]
    v_mfma_f32_16x16x32_bf16 v[48:51], v[32:35], v[212:215], v[48:51]
    s_mov_b32 s44, 61440
    s_waitcnt vmcnt(11)
    buffer_load_dwordx4 v[204:207], v4, s[36:39], s44 offen nt
    s_waitcnt vmcnt(11)
    buffer_load_dwordx4 v[208:211], v4, s[36:39], s44 offen offset:384 nt
    s_waitcnt vmcnt(11)
    buffer_load_dwordx4 v[212:215], v5, s[36:39], s44 offen nt
    v_and_b32 v36, v59, v6
    v_and_b32 v37, v59, v7
    v_and_b32 v38, v59, v8
    v_and_b32 v39, v59, v9
    s_waitcnt vmcnt(39)
    s_nop 0
    v_mfma_f32_16x16x32_bf16 v[40:43], v[36:39], v[216:219], v[40:43]
    v_mfma_f32_16x16x32_bf16 v[44:47], v[36:39], v[220:223], v[44:47]
    v_mfma_f32_16x16x32_bf16 v[48:51], v[36:39], v[224:227], v[48:51]
    s_mov_b32 s44, 64512
    s_waitcnt vmcnt(11)
    buffer_load_dwordx4 v[216:219], v4, s[36:39], s44 offen nt
    s_waitcnt vmcnt(11)
    buffer_load_dwordx4 v[220:223], v4, s[36:39], s44 offen offset:384 nt
    s_waitcnt vmcnt(11)
    buffer_load_dwordx4 v[224:227], v5, s[36:39], s44 offen nt
    v_and_b32 v32, v60, v6
    v_and_b32 v33, v60, v7
    v_and_b32 v34, v60, v8
    v_and_b32 v35, v60, v9
    s_waitcnt vmcnt(39)
    s_nop 0
    v_mfma_f32_16x16x32_bf16 v[40:43], v[32:35], v[228:231], v[40:43]
    v_mfma_f32_16x16x32_bf16 v[44:47], v[32:35], v[232:235], v[44:47]
    v_mfma_f32_16x16x32_bf16 v[48:51], v[32:35], v[236:239], v[48:51]
    s_mov_b32 s44, 67584
    s_waitcnt vmcnt(11)
    buffer_load_dwordx4 v[228:231], v4, s[36:39], s44 offen nt
    s_waitcnt vmcnt(11)
    buffer_load_dwordx4 v[232:235], v4, s[36:39], s44 offen offset:384 nt
    s_waitcnt vmcnt(11)
    buffer_load_dwordx4 v[236:239], v5, s[36:39], s44 offen nt
    v_and_b32 v36, v61, v6
    v_and_b32 v37, v61, v7
    v_and_b32 v38, v61, v8
    v_and_b32 v39, v61, v9
    s_waitcnt vmcnt(39)
    s_nop 0
    v_mfma_f32_16x16x32_bf16 v[40:43], v[36:39], v[240:243], v[40:43]
    v_mfma_f32_16x16x32_bf16 v[44:47], v[36:39], v[244:247], v[44:47]
    v_mfma_f32_16x16x32_bf16 v[48:51], v[36:39], v[248:251], v[48:51]
    s_mov_b32 s44, 70656
    s_waitcnt vmcnt(11)
    buffer_load_dwordx4 v[240:243], v4, s[36:39], s44 offen nt
    s_waitcnt vmcnt(11)
    buffer_load_dwordx4 v[244:247], v4, s[36:39], s44 offen offset:384 nt
    s_waitcnt vmcnt(11)
    buffer_load_dwordx4 v[248:251], v5, s[36:39], s44 offen nt
    v_and_b32 v32, v62, v6
    v_and_b32 v33, v62, v7
    v_and_b32 v34, v62, v8
    v_and_b32 v35, v62, v9
    s_waitcnt vmcnt(39)
    s_nop 0
    v_mfma_f32_16x16x32_bf16 v[40:43], v[32:35], v[84:87], v[40:43]
    v_mfma_f32_16x16x32_bf16 v[44:47], v[32:35], v[88:91], v[44:47]
    v_mfma_f32_16x16x32_bf16 v[48:51], v[32:35], v[92:95], v[48:51]
    s_mov_b32 s44, 73728
    s_waitcnt vmcnt(11)
    buffer_load_dwordx4 v[84:87], v4, s[36:39], s44 offen nt
    s_waitcnt vmcnt(11)
    buffer_load_dwordx4 v[88:91], v4, s[36:39], s44 offen offset:384 nt
    s_waitcnt vmcnt(11)
    buffer_load_dwordx4 v[92:95], v5, s[36:39], s44 offen nt
    v_and_b32 v36, v63, v6
    v_and_b32 v37, v63, v7
    v_and_b32 v38, v63, v8
    v_and_b32 v39, v63, v9
    s_waitcnt vmcnt(39)
    s_nop 0
    v_mfma_f32_16x16x32_bf16 v[40:43], v[36:39], v[96:99], v[40:43]
    v_mfma_f32_16x16x32_bf16 v[44:47], v[36:39], v[100:103], v[44:47]
    v_mfma_f32_16x16x32_bf16 v[48:51], v[36:39], v[104:107], v[48:51]
    s_mov_b32 s44, 76800
    s_waitcnt vmcnt(11)
    buffer_load_dwordx4 v[96:99], v4, s[36:39], s44 offen nt
    s_waitcnt vmcnt(11)
    buffer_load_dwordx4 v[100:103], v4, s[36:39], s44 offen offset:384 nt
    s_waitcnt vmcnt(11)
    buffer_load_dwordx4 v[104:107], v5, s[36:39], s44 offen nt
    v_and_b32 v32, v64, v6
    v_and_b32 v33, v64, v7
    v_and_b32 v34, v64, v8
    v_and_b32 v35, v64, v9
    s_waitcnt vmcnt(39)
    s_nop 0
    v_mfma_f32_16x16x32_bf16 v[40:43], v[32:35], v[108:111], v[40:43]
    v_mfma_f32_16x16x32_bf16 v[44:47], v[32:35], v[112:115], v[44:47]
    v_mfma_f32_16x16x32_bf16 v[48:51], v[32:35], v[116:119], v[48:51]
    s_mov_b32 s44, 79872
    s_waitcnt vmcnt(11)
    buffer_load_dwordx4 v[108:111], v4, s[36:39], s44 offen nt
    s_waitcnt vmcnt(11)
    buffer_load_dwordx4 v[112:115], v4, s[36:39], s44 offen offset:384 nt
    s_waitcnt vmcnt(11)
    buffer_load_dwordx4 v[116:119], v5, s[36:39], s44 offen nt
    v_and_b32 v36, v65, v6
    v_and_b32 v37, v65, v7
    v_and_b32 v38, v65, v8
    v_and_b32 v39, v65, v9
    s_waitcnt vmcnt(39)
    s_nop 0
    v_mfma_f32_16x16x32_bf16 v[40:43], v[36:39], v[120:123], v[40:43]
    v_mfma_f32_16x16x32_bf16 v[44:47], v[36:39], v[124:127], v[44:47]
    v_mfma_f32_16x16x32_bf16 v[48:51], v[36:39], v[128:131], v[48:51]
    s_mov_b32 s44, 82944
    s_waitcnt vmcnt(11)
    buffer_load_dwordx4 v[120:123], v4, s[36:39], s44 offen nt
    s_waitcnt vmcnt(11)
    buffer_load_dwordx4 v[124:127], v4, s[36:39], s44 offen offset:384 nt
    s_waitcnt vmcnt(11)
    buffer_load_dwordx4 v[128:131], v5, s[36:39], s44 offen nt
    v_and_b32 v32, v66, v6
    v_and_b32 v33, v66, v7
    v_and_b32 v34, v66, v8
    v_and_b32 v35, v66, v9
    s_waitcnt vmcnt(39)
    s_nop 0
    v_mfma_f32_16x16x32_bf16 v[40:43], v[32:35], v[132:135], v[40:43]
    v_mfma_f32_16x16x32_bf16 v[44:47], v[32:35], v[136:139], v[44:47]
    v_mfma_f32_16x16x32_bf16 v[48:51], v[32:35], v[140:143], v[48:51]
    s_mov_b32 s44, 86016
    s_waitcnt vmcnt(11)
    buffer_load_dwordx4 v[132:135], v4, s[36:39], s44 offen nt
    s_waitcnt vmcnt(11)
    buffer_load_dwordx4 v[136:139], v4, s[36:39], s44 offen offset:384 nt
    s_waitcnt vmcnt(11)
    buffer_load_dwordx4 v[140:143], v5, s[36:39], s44 offen nt
    v_and_b32 v36, v67, v6
    v_and_b32 v37, v67, v7
    v_and_b32 v38, v67, v8
    v_and_b32 v39, v67, v9
    s_waitcnt vmcnt(39)
    s_nop 0
    v_mfma_f32_16x16x32_bf16 v[40:43], v[36:39], v[144:147], v[40:43]
    v_mfma_f32_16x16x32_bf16 v[44:47], v[36:39], v[148:151], v[44:47]
    v_mfma_f32_16x16x32_bf16 v[48:51], v[36:39], v[152:155], v[48:51]
    s_mov_b32 s44, 89088
    s_waitcnt vmcnt(11)
    buffer_load_dwordx4 v[144:147], v4, s[36:39], s44 offen nt
    s_waitcnt vmcnt(11)
    buffer_load_dwordx4 v[148:151], v4, s[36:39], s44 offen offset:384 nt
    s_waitcnt vmcnt(11)
    buffer_load_dwordx4 v[152:155], v5, s[36:39], s44 offen nt
    v_and_b32 v32, v68, v6
    v_and_b32 v33, v68, v7
    v_and_b32 v34, v68, v8
    v_and_b32 v35, v68, v9
    s_waitcnt vmcnt(39)
    s_nop 0
    v_mfma_f32_16x16x32_bf16 v[40:43], v[32:35], v[156:159], v[40:43]
    v_mfma_f32_16x16x32_bf16 v[44:47], v[32:35], v[160:163], v[44:47]
    v_mfma_f32_16x16x32_bf16 v[48:51], v[32:35], v[164:167], v[48:51]
    s_mov_b32 s44, 92160
    s_waitcnt vmcnt(11)
    buffer_load_dwordx4 v[156:159], v4, s[36:39], s44 offen nt
    s_waitcnt vmcnt(11)
    buffer_load_dwordx4 v[160:163], v4, s[36:39], s44 offen offset:384 nt
    s_waitcnt vmcnt(11)
    buffer_load_dwordx4 v[164:167], v5, s[36:39], s44 offen nt
    v_and_b32 v36, v69, v6
    v_and_b32 v37, v69, v7
    v_and_b32 v38, v69, v8
    v_and_b32 v39, v69, v9
    s_waitcnt vmcnt(39)
    s_nop 0
    v_mfma_f32_16x16x32_bf16 v[40:43], v[36:39], v[168:171], v[40:43]
    v_mfma_f32_16x16x32_bf16 v[44:47], v[36:39], v[172:175], v[44:47]
    v_mfma_f32_16x16x32_bf16 v[48:51], v[36:39], v[176:179], v[48:51]
    s_mov_b32 s44, 95232
    s_waitcnt vmcnt(11)
    buffer_load_dwordx4 v[168:171], v4, s[36:39], s44 offen nt
    s_waitcnt vmcnt(11)
    buffer_load_dwordx4 v[172:175], v4, s[36:39], s44 offen offset:384 nt
    s_waitcnt vmcnt(11)
    buffer_load_dwordx4 v[176:179], v5, s[36:39], s44 offen nt
    v_and_b32 v32, v70, v6
    v_and_b32 v33, v70, v7
    v_and_b32 v34, v70, v8
    v_and_b32 v35, v70, v9
    s_waitcnt vmcnt(39)
    s_nop 0
    v_mfma_f32_16x16x32_bf16 v[40:43], v[32:35], v[180:183], v[40:43]
    v_mfma_f32_16x16x32_bf16 v[44:47], v[32:35], v[184:187], v[44:47]
    v_mfma_f32_16x16x32_bf16 v[48:51], v[32:35], v[188:191], v[48:51]
    v_and_b32 v36, v71, v6
    v_and_b32 v37, v71, v7
    v_and_b32 v38, v71, v8
    v_and_b32 v39, v71, v9
    s_waitcnt vmcnt(36)
    s_nop 0
    v_mfma_f32_16x16x32_bf16 v[40:43], v[36:39], v[192:195], v[40:43]
    v_mfma_f32_16x16x32_bf16 v[44:47], v[36:39], v[196:199], v[44:47]
    v_mfma_f32_16x16x32_bf16 v[48:51], v[36:39], v[200:203], v[48:51]
    v_and_b32 v32, v72, v6
    v_and_b32 v33, v72, v7
    v_and_b32 v34, v72, v8
    v_and_b32 v35, v72, v9
    s_waitcnt vmcnt(33)
    s_nop 0
    v_mfma_f32_16x16x32_bf16 v[40:43], v[32:35], v[204:207], v[40:43]
    v_mfma_f32_16x16x32_bf16 v[44:47], v[32:35], v[208:211], v[44:47]
    v_mfma_f32_16x16x32_bf16 v[48:51], v[32:35], v[212:215], v[48:51]
    v_and_b32 v36, v73, v6
    v_and_b32 v37, v73, v7
    v_and_b32 v38, v73, v8
    v_and_b32 v39, v73, v9
    s_waitcnt vmcnt(30)
    s_nop 0
    v_mfma_f32_16x16x32_bf16 v[40:43], v[36:39], v[216:219], v[40:43]
    v_mfma_f32_16x16x32_bf16 v[44:47], v[36:39], v[220:223], v[44:47]
    v_mfma_f32_16x16x32_bf16 v[48:51], v[36:39], v[224:227], v[48:51]
    v_and_b32 v32, v74, v6
    v_and_b32 v33, v74, v7
    v_and_b32 v34, v74, v8
    v_and_b32 v35, v74, v9
    s_waitcnt vmcnt(27)
    s_nop 0
    v_mfma_f32_16x16x32_bf16 v[40:43], v[32:35], v[228:231], v[40:43]
    v_mfma_f32_16x16x32_bf16 v[44:47], v[32:35], v[232:235], v[44:47]
    v_mfma_f32_16x16x32_bf16 v[48:51], v[32:35], v[236:239], v[48:51]
    v_and_b32 v36, v75, v6
    v_and_b32 v37, v75, v7
    v_and_b32 v38, v75, v8
    v_and_b32 v39, v75, v9
    s_waitcnt vmcnt(24)
    s_nop 0
    v_mfma_f32_16x16x32_bf16 v[40:43], v[36:39], v[240:243], v[40:43]
    v_mfma_f32_16x16x32_bf16 v[44:47], v[36:39], v[244:247], v[44:47]
    v_mfma_f32_16x16x32_bf16 v[48:51], v[36:39], v[248:251], v[48:51]
    v_and_b32 v32, v76, v6
    v_and_b32 v33, v76, v7
    v_and_b32 v34, v76, v8
    v_and_b32 v35, v76, v9
    s_waitcnt vmcnt(21)
    s_nop 0
    v_mfma_f32_16x16x32_bf16 v[40:43], v[32:35], v[84:87], v[40:43]
    v_mfma_f32_16x16x32_bf16 v[44:47], v[32:35], v[88:91], v[44:47]
    v_mfma_f32_16x16x32_bf16 v[48:51], v[32:35], v[92:95], v[48:51]
    v_and_b32 v36, v77, v6
    v_and_b32 v37, v77, v7
    v_and_b32 v38, v77, v8
    v_and_b32 v39, v77, v9
    s_waitcnt vmcnt(18)
    s_nop 0
    v_mfma_f32_16x16x32_bf16 v[40:43], v[36:39], v[96:99], v[40:43]
    v_mfma_f32_16x16x32_bf16 v[44:47], v[36:39], v[100:103], v[44:47]
    v_mfma_f32_16x16x32_bf16 v[48:51], v[36:39], v[104:107], v[48:51]
    v_and_b32 v32, v78, v6
    v_and_b32 v33, v78, v7
    v_and_b32 v34, v78, v8
    v_and_b32 v35, v78, v9
    s_waitcnt vmcnt(15)
    s_nop 0
    v_mfma_f32_16x16x32_bf16 v[40:43], v[32:35], v[108:111], v[40:43]
    v_mfma_f32_16x16x32_bf16 v[44:47], v[32:35], v[112:115], v[44:47]
    v_mfma_f32_16x16x32_bf16 v[48:51], v[32:35], v[116:119], v[48:51]
    v_and_b32 v36, v79, v6
    v_and_b32 v37, v79, v7
    v_and_b32 v38, v79, v8
    v_and_b32 v39, v79, v9
    s_waitcnt vmcnt(12)
    s_nop 0
    v_mfma_f32_16x16x32_bf16 v[40:43], v[36:39], v[120:123], v[40:43]
    v_mfma_f32_16x16x32_bf16 v[44:47], v[36:39], v[124:127], v[44:47]
    v_mfma_f32_16x16x32_bf16 v[48:51], v[36:39], v[128:131], v[48:51]
    v_and_b32 v32, v80, v6
    v_and_b32 v33, v80, v7
    v_and_b32 v34, v80, v8
    v_and_b32 v35, v80, v9
    s_waitcnt vmcnt(9)
    s_nop 0
    v_mfma_f32_16x16x32_bf16 v[40:43], v[32:35], v[132:135], v[40:43]
    v_mfma_f32_16x16x32_bf16 v[44:47], v[32:35], v[136:139], v[44:47]
    v_mfma_f32_16x16x32_bf16 v[48:51], v[32:35], v[140:143], v[48:51]
    v_and_b32 v36, v81, v6
    v_and_b32 v37, v81, v7
    v_and_b32 v38, v81, v8
    v_and_b32 v39, v81, v9
    s_waitcnt vmcnt(6)
    s_nop 0
    v_mfma_f32_16x16x32_bf16 v[40:43], v[36:39], v[144:147], v[40:43]
    v_mfma_f32_16x16x32_bf16 v[44:47], v[36:39], v[148:151], v[44:47]
    v_mfma_f32_16x16x32_bf16 v[48:51], v[36:39], v[152:155], v[48:51]
    v_and_b32 v32, v82, v6
    v_and_b32 v33, v82, v7
    v_and_b32 v34, v82, v8
    v_and_b32 v35, v82, v9
    s_waitcnt vmcnt(3)
    s_nop 0
    v_mfma_f32_16x16x32_bf16 v[40:43], v[32:35], v[156:159], v[40:43]
    v_mfma_f32_16x16x32_bf16 v[44:47], v[32:35], v[160:163], v[44:47]
    v_mfma_f32_16x16x32_bf16 v[48:51], v[32:35], v[164:167], v[48:51]
    v_and_b32 v36, v83, v6
    v_and_b32 v37, v83, v7
    v_and_b32 v38, v83, v8
    v_and_b32 v39, v83, v9
    s_waitcnt vmcnt(0)
    s_nop 0
    v_mfma_f32_16x16x32_bf16 v[40:43], v[36:39], v[168:171], v[40:43]
    v_mfma_f32_16x16x32_bf16 v[44:47], v[36:39], v[172:175], v[44:47]
    v_mfma_f32_16x16x32_bf16 v[48:51], v[36:39], v[176:179], v[48:51]
    s_branch L_Tjoin
L_Todd:
    s_barrier
    s_mov_b32 s44, 0
    buffer_load_dwordx4 v[84:87], v4, s[32:35], s44 offen nt
    buffer_load_dwordx4 v[88:91], v4, s[32:35], s44 offen offset:384 nt
    buffer_load_dwordx4 v[92:95], v5, s[32:35], s44 offen nt
    s_mov_b32 s44, 3072
    buffer_load_dwordx4 v[96:99], v4, s[32:35], s44 offen nt
    buffer_load_dwordx4 v[100:103], v4, s[32:35], s44 offen offset:384 nt
    buffer_load_dwordx4 v[104:107], v5, s[32:35], s44 offen nt
    s_mov_b32 s44, 6144
    buffer_load_dwordx4 v[108:111], v4, s[32:35], s44 offen nt
    buffer_load_dwordx4 v[112:115], v4, s[32:35], s44 offen offset:384 nt
    buffer_load_dwordx4 v[116:119], v5, s[32:35], s44 offen nt
    s_mov_b32 s44, 9216
    buffer_load_dwordx4 v[120:123], v4, s[32:35], s44 offen nt
    buffer_load_dwordx4 v[124:127], v4, s[32:35], s44 offen offset:384 nt
    buffer_load_dwordx4 v[128:131], v5, s[32:35], s44 offen nt
    s_mov_b32 s44, 12288
    buffer_load_dwordx4 v[132:135], v4, s[32:35], s44 offen nt
    buffer_load_dwordx4 v[136:139], v4, s[32:35], s44 offen offset:384 nt
    buffer_load_dwordx4 v[140:143], v5, s[32:35], s44 offen nt
    s_mov_b32 s44, 15360
    buffer_load_dwordx4 v[144:147], v4, s[32:35], s44 offen nt
    buffer_load_dwordx4 v[148:151], v4, s[32:35], s44 offen offset:384 nt
    buffer_load_dwordx4 v[152:155], v5, s[32:35], s44 offen nt
    s_mov_b32 s44, 18432
    buffer_load_dwordx4 v[156:159], v4, s[32:35], s44 offen nt
    buffer_load_dwordx4 v[160:163], v4, s[32:35], s44 offen offset:384 nt
    buffer_load_dwordx4 v[164:167], v5, s[32:35], s44 offen nt
    s_mov_b32 s44, 21504
    buffer_load_dwordx4 v[168:171], v4, s[32:35], s44 offen nt
    buffer_load_dwordx4 v[172:175], v4, s[32:35], s44 offen offset:384 nt
    buffer_load_dwordx4 v[176:179], v5, s[32:35], s44 offen nt
    s_mov_b32 s44, 24576
    s_waitcnt vmcnt(23)
    buffer_load_dwordx4 v[180:183], v4, s[32:35], s44 offen nt
    s_waitcnt vmcnt(23)
    buffer_load_dwordx4 v[184:187], v4, s[32:35], s44 offen offset:384 nt
    s_waitcnt vmcnt(23)
    buffer_load_dwordx4 v[188:191], v5, s[32:35], s44 offen nt
    s_mov_b32 s44, 27648
    s_waitcnt vmcnt(23)
    buffer_load_dwordx4 v[192:195], v4, s[32:35], s44 offen nt
    s_waitcnt vmcnt(23)
    buffer_load_dwordx4 v[196:199], v4, s[32:35], s44 offen offset:384 nt
    s_waitcnt vmcnt(23)
    buffer_load_dwordx4 v[200:203], v5, s[32:35], s44 offen nt
    s_mov_b32 s44, 30720
    s_waitcnt vmcnt(23)
    buffer_load_dwordx4 v[204:207], v4, s[32:35], s44 offen nt
    s_waitcnt vmcnt(23)
    buffer_load_dwordx4 v[208:211], v4, s[32:35], s44 offen offset:384 nt
    s_waitcnt vmcnt(23)
    buffer_load_dwordx4 v[212:215], v5, s[32:35], s44 offen nt
    s_mov_b32 s44, 33792
    s_waitcnt vmcnt(23)
    buffer_load_dwordx4 v[216:219], v4, s[32:35], s44 offen nt
    s_waitcnt vmcnt(23)
    buffer_load_dwordx4 v[220:223], v4, s[32:35], s44 offen offset:384 nt
    s_waitcnt vmcnt(23)
    buffer_load_dwordx4 v[224:227], v5, s[32:35], s44 offen nt
    s_mov_b32 s44, 36864
    s_waitcnt vmcnt(23)
    buffer_load_dwordx4 v[228:231], v4, s[32:35], s44 offen nt
    s_waitcnt vmcnt(23)
    buffer_load_dwordx4 v[232:235], v4, s[32:35], s44 offen offset:384 nt
    s_waitcnt vmcnt(23)
    buffer_load_dwordx4 v[236:239], v5, s[32:35], s44 offen nt
    s_mov_b32 s44, 39936
    s_waitcnt vmcnt(23)
    buffer_load_dwordx4 v[240:243], v4, s[32:35], s44 offen nt
    s_waitcnt vmcnt(23)
    buffer_load_dwordx4 v[244:247], v4, s[32:35], s44 offen offset:384 nt
    s_waitcnt vmcnt(23)
    buffer_load_dwordx4 v[248:251], v5, s[32:35], s44 offen nt
    v_and_b32 v10, 1, v3
    v_cmp_eq_u32 vcc, 1, v10
    v_mov_b32 v11, 0xffff
    v_mov_b32 v10, 0xffff0000
    v_cndmask_b32 v11, v11, v10, vcc
    v_bfe_u32 v10, v3, 1, 2
    v_cmp_eq_u32 vcc, 0, v10
    s_nop 1
    v_cndmask_b32 v6, 0, v11, vcc
    v_cmp_eq_u32 vcc, 1, v10
    s_nop 1
    v_cndmask_b32 v7, 0, v11, vcc
    v_cmp_eq_u32 vcc, 2, v10
    s_nop 1
    v_cndmask_b32 v8, 0, v11, vcc
    v_cmp_eq_u32 vcc, 3, v10
    s_nop 1
    v_cndmask_b32 v9, 0, v11, vcc
    v_lshlrev_b32 v10, 4, v3
    v_and_b32 v11, 7, v3
    v_lshlrev_b32 v11, 4, v11
    s_mov_b32 s48, 0x3d93cd3a
    s_mov_b32 s49, 0x3d93cd3a
    s_mov_b32 s50, 0x3fb8aa3b
    s_mov_b32 s51, 0x3fb8aa3b
    v_mov_b32 v30, 0xff800000
    s_barrier
    ds_read_b128 v[12:15], v10 offset:0
    ds_read_b128 v[16:19], v11 offset:256
    s_waitcnt lgkmcnt(0)
    s_waitcnt vmcnt(39)
    v_dot2_f32_bf16 v20, v84, v12, 0
    v_dot2_f32_bf16 v21, v88, v12, 0
    v_dot2_f32_bf16 v22, v92, v16, 0
    v_dot2_f32_bf16 v20, v85, v13, v20
    v_dot2_f32_bf16 v21, v89, v13, v21
    v_dot2_f32_bf16 v22, v93, v17, v22
    v_dot2_f32_bf16 v20, v86, v14, v20
    v_dot2_f32_bf16 v21, v90, v14, v21
    v_dot2_f32_bf16 v22, v94, v18, v22
    v_dot2_f32_bf16 v20, v87, v15, v20
    v_dot2_f32_bf16 v21, v91, v15, v21
    v_dot2_f32_bf16 v22, v95, v19, v22
    s_mov_b32 s44, 43008
    s_waitcnt vmcnt(23)
    buffer_load_dwordx4 v[84:87], v4, s[32:35], s44 offen nt
    s_waitcnt vmcnt(23)
    buffer_load_dwordx4 v[88:91], v4, s[32:35], s44 offen offset:384 nt
    s_waitcnt vmcnt(23)
    buffer_load_dwordx4 v[92:95], v5, s[32:35], s44 offen nt
    s_waitcnt vmcnt(39)
    v_dot2_f32_bf16 v23, v96, v12, 0
    v_add_f32_dpp v26, v20, v20 row_ror:8 row_mask:0xf bank_mask:0xf
    v_dot2_f32_bf16 v24, v100, v12, 0
    v_dot2_f32_bf16 v25, v104, v16, 0
    v_add_f32_dpp v26, v21, v21 row_ror:8 row_mask:0xf bank_mask:0xc
    v_dot2_f32_bf16 v23, v97, v13, v23
    v_dot2_f32_bf16 v24, v101, v13, v24
    v_add_f32 v26, v26, v22
    v_dot2_f32_bf16 v25, v105, v17, v25
    v_dot2_f32_bf16 v23, v98, v14, v23
    v_add_f32_dpp v26, v26, v26 quad_perm:[1,0,3,2] row_mask:0xf bank_mask:0xf
    v_dot2_f32_bf16 v24, v102, v14, v24
    v_dot2_f32_bf16 v25, v106, v18, v25
    v_add_f32_dpp v26, v26, v26 quad_perm:[2,3,0,1] row_mask:0xf bank_mask:0xf
    v_dot2_f32_bf16 v23, v99, v15, v23
    v_dot2_f32_bf16 v24, v103, v15, v24
    v_add_f32_dpp v26, v26, v26 row_half_mirror row_mask:0xf bank_mask:0xf
    v_dot2_f32_bf16 v25, v107, v19, v25
    s_mov_b32 s44, 46080
    s_waitcnt vmcnt(23)
    buffer_load_dwordx4 v[96:99], v4, s[32:35], s44 offen nt
    s_waitcnt vmcnt(23)
    buffer_load_dwordx4 v[100:103], v4, s[32:35], s44 offen offset:384 nt
    s_waitcnt vmcnt(23)
    buffer_load_dwordx4 v[104:107], v5, s[32:35], s44 offen nt
    s_waitcnt vmcnt(39)
    v_dot2_f32_bf16 v20, v108, v12, 0
    v_add_f32_dpp v27, v23, v23 row_ror:8 row_mask:0xf bank_mask:0xf
    v_dot2_f32_bf16 v21, v112, v12, 0
    v_dot2_f32_bf16 v22, v116, v16, 0
    v_add_f32_dpp v27, v24, v24 row_ror:8 row_mask:0xf bank_mask:0xc
    v_dot2_f32_bf16 v20, v109, v13, v20
    v_dot2_f32_bf16 v21, v113, v13, v21
    v_add_f32 v27, v27, v25
    v_dot2_f32_bf16 v22, v117, v17, v22
    v_dot2_f32_bf16 v20, v110, v14, v20
    v_add_f32_dpp v27, v27, v27 quad_perm:[1,0,3,2] row_mask:0xf bank_mask:0xf
    v_dot2_f32_bf16 v21, v114, v14, v21
    v_dot2_f32_bf16 v22, v118, v18, v22
    v_add_f32_dpp v27, v27, v27 quad_perm:[2,3,0,1] row_mask:0xf bank_mask:0xf
    v_dot2_f32_bf16 v20, v111, v15, v20
    v_dot2_f32_bf16 v21, v115, v15, v21
    v_add_f32_dpp v27, v27, v27 row_half_mirror row_mask:0xf bank_mask:0xf
    v_dot2_f32_bf16 v22, v119, v19, v22
    s_mov_b32 s44, 49152
    s_waitcnt vmcnt(23)
    buffer_load_dwordx4 v[108:111], v4, s[32:35], s44 offen nt
    s_waitcnt vmcnt(23)
    buffer_load_dwordx4 v[112:115], v4, s[32:35], s44 offen offset:384 nt
    s_waitcnt vmcnt(23)
    buffer_load_dwordx4 v[116:119], v5, s[32:35], s44 offen nt
    s_waitcnt vmcnt(39)
    v_cvt_pk_bf16_f32 v31, v26, v27
    v_lshlrev_b32 v28, 16, v31
    v_and_b32 v29, 0xffff0000, v31
    v_pk_mul_f32 v[28:29], v[28:29], s[48:49]
    v_cvt_pk_bf16_f32 v31, v28, v29
    v_lshlrev_b32 v52, 16, v31
    v_and_b32 v53, 0xffff0000, v31
    v_max3_f32 v30, v30, v52, v53
    v_dot2_f32_bf16 v23, v120, v12, 0
    v_add_f32_dpp v26, v20, v20 row_ror:8 row_mask:0xf bank_mask:0xf
    v_dot2_f32_bf16 v24, v124, v12, 0
    v_dot2_f32_bf16 v25, v128, v16, 0
    v_add_f32_dpp v26, v21, v21 row_ror:8 row_mask:0xf bank_mask:0xc
    v_dot2_f32_bf16 v23, v121, v13, v23
    v_dot2_f32_bf16 v24, v125, v13, v24
    v_add_f32 v26, v26, v22
    v_dot2_f32_bf16 v25, v129, v17, v25
    v_dot2_f32_bf16 v23, v122, v14, v23
    v_add_f32_dpp v26, v26, v26 quad_perm:[1,0,3,2] row_mask:0xf bank_mask:0xf
    v_dot2_f32_bf16 v24, v126, v14, v24
    v_dot2_f32_bf16 v25, v130, v18, v25
    v_add_f32_dpp v26, v26, v26 quad_perm:[2,3,0,1] row_mask:0xf bank_mask:0xf
    v_dot2_f32_bf16 v23, v123, v15, v23
    v_dot2_f32_bf16 v24, v127, v15, v24
    v_add_f32_dpp v26, v26, v26 row_half_mirror row_mask:0xf bank_mask:0xf
    v_dot2_f32_bf16 v25, v131, v19, v25
    s_mov_b32 s44, 52224
    s_waitcnt vmcnt(23)
    buffer_load_dwordx4 v[120:123], v4, s[32:35], s44 offen nt
    s_waitcnt vmcnt(23)
    buffer_load_dwordx4 v[124:127], v4, s[32:35], s44 offen offset:384 nt
    s_waitcnt vmcnt(23)
    buffer_load_dwordx4 v[128:131], v5, s[32:35], s44 offen nt
    s_waitcnt vmcnt(39)
    v_dot2_f32_bf16 v20, v132, v12, 0
    v_add_f32_dpp v27, v23, v23 row_ror:8 row_mask:0xf bank_mask:0xf
    v_dot2_f32_bf16 v21, v136, v12, 0
    v_dot2_f32_bf16 v22, v140, v16, 0
    v_add_f32_dpp v27, v24, v24 row_ror:8 row_mask:0xf bank_mask:0xc
    v_dot2_f32_bf16 v20, v133, v13, v20
    v_dot2_f32_bf16 v21, v137, v13, v21
    v_add_f32 v27, v27, v25
    v_dot2_f32_bf16 v22, v141, v17, v22
    v_dot2_f32_bf16 v20, v134, v14, v20
    v_add_f32_dpp v27, v27, v27 quad_perm:[1,0,3,2] row_mask:0xf bank_mask:0xf
    v_dot2_f32_bf16 v21, v138, v14, v21
    v_dot2_f32_bf16 v22, v142, v18, v22
    v_add_f32_dpp v27, v27, v27 quad_perm:[2,3,0,1] row_mask:0xf bank_mask:0xf
    v_dot2_f32_bf16 v20, v135, v15, v20
    v_dot2_f32_bf16 v21, v139, v15, v21
    v_add_f32_dpp v27, v27, v27 row_half_mirror row_mask:0xf bank_mask:0xf
    v_dot2_f32_bf16 v22, v143, v19, v22
    s_mov_b32 s44, 55296
    s_waitcnt vmcnt(23)
    buffer_load_dwordx4 v[132:135], v4, s[32:35], s44 offen nt
    s_waitcnt vmcnt(23)
    buffer_load_dwordx4 v[136:139], v4, s[32:35], s44 offen offset:384 nt
    s_waitcnt vmcnt(23)
    buffer_load_dwordx4 v[140:143], v5, s[32:35], s44 offen nt
    s_waitcnt vmcnt(39)
    v_cvt_pk_bf16_f32 v31, v26, v27
    v_lshlrev_b32 v28, 16, v31
    v_and_b32 v29, 0xffff0000, v31
    v_pk_mul_f32 v[28:29], v[28:29], s[48:49]
    v_cvt_pk_bf16_f32 v31, v28, v29
    v_lshlrev_b32 v54, 16, v31
    v_and_b32 v55, 0xffff0000, v31
    v_max3_f32 v30, v30, v54, v55
    v_dot2_f32_bf16 v23, v144, v12, 0
    v_add_f32_dpp v26, v20, v20 row_ror:8 row_mask:0xf bank_mask:0xf
    v_dot2_f32_bf16 v24, v148, v12, 0
    v_dot2_f32_bf16 v25, v152, v16, 0
    v_add_f32_dpp v26, v21, v21 row_ror:8 row_mask:0xf bank_mask:0xc
    v_dot2_f32_bf16 v23, v145, v13, v23
    v_dot2_f32_bf16 v24, v149, v13, v24
    v_add_f32 v26, v26, v22
    v_dot2_f32_bf16 v25, v153, v17, v25
    v_dot2_f32_bf16 v23, v146, v14, v23
    v_add_f32_dpp v26, v26, v26 quad_perm:[1,0,3,2] row_mask:0xf bank_mask:0xf
    v_dot2_f32_bf16 v24, v150, v14, v24
    v_dot2_f32_bf16 v25, v154, v18, v25
    v_add_f32_dpp v26, v26, v26 quad_perm:[2,3,0,1] row_mask:0xf bank_mask:0xf
    v_dot2_f32_bf16 v23, v147, v15, v23
    v_dot2_f32_bf16 v24, v151, v15, v24
    v_add_f32_dpp v26, v26, v26 row_half_mirror row_mask:0xf bank_mask:0xf
    v_dot2_f32_bf16 v25, v155, v19, v25
    s_mov_b32 s44, 58368
    s_waitcnt vmcnt(23)
    buffer_load_dwordx4 v[144:147], v4, s[32:35], s44 offen nt
    s_waitcnt vmcnt(23)
    buffer_load_dwordx4 v[148:151], v4, s[32:35], s44 offen offset:384 nt
    s_waitcnt vmcnt(23)
    buffer_load_dwordx4 v[152:155], v5, s[32:35], s44 offen nt
    s_waitcnt vmcnt(39)
    v_dot2_f32_bf16 v20, v156, v12, 0
    v_add_f32_dpp v27, v23, v23 row_ror:8 row_mask:0xf bank_mask:0xf
    v_dot2_f32_bf16 v21, v160, v12, 0
    v_dot2_f32_bf16 v22, v164, v16, 0
    v_add_f32_dpp v27, v24, v24 row_ror:8 row_mask:0xf bank_mask:0xc
    v_dot2_f32_bf16 v20, v157, v13, v20
    v_dot2_f32_bf16 v21, v161, v13, v21
    v_add_f32 v27, v27, v25
    v_dot2_f32_bf16 v22, v165, v17, v22
    v_dot2_f32_bf16 v20, v158, v14, v20
    v_add_f32_dpp v27, v27, v27 quad_perm:[1,0,3,2] row_mask:0xf bank_mask:0xf
    v_dot2_f32_bf16 v21, v162, v14, v21
    v_dot2_f32_bf16 v22, v166, v18, v22
    v_add_f32_dpp v27, v27, v27 quad_perm:[2,3,0,1] row_mask:0xf bank_mask:0xf
    v_dot2_f32_bf16 v20, v159, v15, v20
    v_dot2_f32_bf16 v21, v163, v15, v21
    v_add_f32_dpp v27, v27, v27 row_half_mirror row_mask:0xf bank_mask:0xf
    v_dot2_f32_bf16 v22, v167, v19, v22
    s_mov_b32 s44, 61440
    s_waitcnt vmcnt(23)
    buffer_load_dwordx4 v[156:159], v4, s[32:35], s44 offen nt
    s_waitcnt vmcnt(23)
    buffer_load_dwordx4 v[160:163], v4, s[32:35], s44 offen offset:384 nt
    s_waitcnt vmcnt(23)
    buffer_load_dwordx4 v[164:167], v5, s[32:35], s44 offen nt
    s_waitcnt vmcnt(39)
    v_cvt_pk_bf16_f32 v31, v26, v27
    v_lshlrev_b32 v28, 16, v31
    v_and_b32 v29, 0xffff0000, v31
    v_pk_mul_f32 v[28:29], v[28:29], s[48:49]
    v_cvt_pk_bf16_f32 v31, v28, v29
    v_lshlrev_b32 v56, 16, v31
    v_and_b32 v57, 0xffff0000, v31
    v_max3_f32 v30, v30, v56, v57
    v_dot2_f32_bf16 v23, v168, v12, 0
    v_add_f32_dpp v26, v20, v20 row_ror:8 row_mask:0xf bank_mask:0xf
    v_dot2_f32_bf16 v24, v172, v12, 0
    v_dot2_f32_bf16 v25, v176, v16, 0
    v_add_f32_dpp v26, v21, v21 row_ror:8 row_mask:0xf bank_mask:0xc
    v_dot2_f32_bf16 v23, v169, v13, v23
    v_dot2_f32_bf16 v24, v173, v13, v24
    v_add_f32 v26, v26, v22
    v_dot2_f32_bf16 v25, v177, v17, v25
    v_dot2_f32_bf16 v23, v170, v14, v23
    v_add_f32_dpp v26, v26, v26 quad_perm:[1,0,3,2] row_mask:0xf bank_mask:0xf
    v_dot2_f32_bf16 v24, v174, v14, v24
    v_dot2_f32_bf16 v25, v178, v18, v25
    v_add_f32_dpp v26, v26, v26 quad_perm:[2,3,0,1] row_mask:0xf bank_mask:0xf
    v_dot2_f32_bf16 v23, v171, v15, v23
    v_dot2_f32_bf16 v24, v175, v15, v24
    v_add_f32_dpp v26, v26, v26 row_half_mirror row_mask:0xf bank_mask:0xf
    v_dot2_f32_bf16 v25, v179, v19, v25
    s_mov_b32 s44, 64512
    s_waitcnt vmcnt(23)
    buffer_load_dwordx4 v[168:171], v4, s[32:35], s44 offen nt
    s_waitcnt vmcnt(23)
    buffer_load_dwordx4 v[172:175], v4, s[32:35], s44 offen offset:384 nt
    s_waitcnt vmcnt(23)
    buffer_load_dwordx4 v[176:179], v5, s[32:35], s44 offen nt
    s_waitcnt vmcnt(39)
    v_dot2_f32_bf16 v20, v180, v12, 0
    v_add_f32_dpp v27, v23, v23 row_ror:8 row_mask:0xf bank_mask:0xf
    v_dot2_f32_bf16 v21, v184, v12, 0
    v_dot2_f32_bf16 v22, v188, v16, 0
    v_add_f32_dpp v27, v24, v24 row_ror:8 row_mask:0xf bank_mask:0xc
    v_dot2_f32_bf16 v20, v181, v13, v20
    v_dot2_f32_bf16 v21, v185, v13, v21
    v_add_f32 v27, v27, v25
    v_dot2_f32_bf16 v22, v189, v17, v22
    v_dot2_f32_bf16 v20, v182, v14, v20
    v_add_f32_dpp v27, v27, v27 quad_perm:[1,0,3,2] row_mask:0xf bank_mask:0xf
    v_dot2_f32_bf16 v21, v186, v14, v21
    v_dot2_f32_bf16 v22, v190, v18, v22
    v_add_f32_dpp v27, v27, v27 quad_perm:[2,3,0,1] row_mask:0xf bank_mask:0xf
    v_dot2_f32_bf16 v20, v183, v15, v20
    v_dot2_f32_bf16 v21, v187, v15, v21
    v_add_f32_dpp v27, v27, v27 row_half_mirror row_mask:0xf bank_mask:0xf
    v_dot2_f32_bf16 v22, v191, v19, v22
    s_mov_b32 s44, 67584
    s_waitcnt vmcnt(23)
    buffer_load_dwordx4 v[180:183], v4, s[32:35], s44 offen nt
    s_waitcnt vmcnt(23)
    buffer_load_dwordx4 v[184:187], v4, s[32:35], s44 offen offset:384 nt
    s_waitcnt vmcnt(23)
    buffer_load_dwordx4 v[188:191], v5, s[32:35], s44 offen nt
    s_waitcnt vmcnt(39)
    v_cvt_pk_bf16_f32 v31, v26, v27
    v_lshlrev_b32 v28, 16, v31
    v_and_b32 v29, 0xffff0000, v31
    v_pk_mul_f32 v[28:29], v[28:29], s[48:49]
    v_cvt_pk_bf16_f32 v31, v28, v29
    v_lshlrev_b32 v58, 16, v31
    v_and_b32 v59, 0xffff0000, v31
    v_max3_f32 v30, v30, v58, v59
    v_dot2_f32_bf16 v23, v192, v12, 0
    v_add_f32_dpp v26, v20, v20 row_ror:8 row_mask:0xf bank_mask:0xf
    v_dot2_f32_bf16 v24, v196, v12, 0
    v_dot2_f32_bf16 v25, v200, v16, 0
    v_add_f32_dpp v26, v21, v21 row_ror:8 row_mask:0xf bank_mask:0xc
    v_dot2_f32_bf16 v23, v193, v13, v23
    v_dot2_f32_bf16 v24, v197, v13, v24
    v_add_f32 v26, v26, v22
    v_dot2_f32_bf16 v25, v201, v17, v25
    v_dot2_f32_bf16 v23, v194, v14, v23
    v_add_f32_dpp v26, v26, v26 quad_perm:[1,0,3,2] row_mask:0xf bank_mask:0xf
    v_dot2_f32_bf16 v24, v198, v14, v24
    v_dot2_f32_bf16 v25, v202, v18, v25
    v_add_f32_dpp v26, v26, v26 quad_perm:[2,3,0,1] row_mask:0xf bank_mask:0xf
    v_dot2_f32_bf16 v23, v195, v15, v23
    v_dot2_f32_bf16 v24, v199, v15, v24
    v_add_f32_dpp v26, v26, v26 row_half_mirror row_mask:0xf bank_mask:0xf
    v_dot2_f32_bf16 v25, v203, v19, v25
    s_mov_b32 s44, 70656
    s_waitcnt vmcnt(23)
    buffer_load_dwordx4 v[192:195], v4, s[32:35], s44 offen nt
    s_waitcnt vmcnt(23)
    buffer_load_dwordx4 v[196:199], v4, s[32:35], s44 offen offset:384 nt
    s_waitcnt vmcnt(23)
    buffer_load_dwordx4 v[200:203], v5, s[32:35], s44 offen nt
    s_waitcnt vmcnt(39)
    v_dot2_f32_bf16 v20, v204, v12, 0
    v_add_f32_dpp v27, v23, v23 row_ror:8 row_mask:0xf bank_mask:0xf
    v_dot2_f32_bf16 v21, v208, v12, 0
    v_dot2_f32_bf16 v22, v212, v16, 0
    v_add_f32_dpp v27, v24, v24 row_ror:8 row_mask:0xf bank_mask:0xc
    v_dot2_f32_bf16 v20, v205, v13, v20
    v_dot2_f32_bf16 v21, v209, v13, v21
    v_add_f32 v27, v27, v25
    v_dot2_f32_bf16 v22, v213, v17, v22
    v_dot2_f32_bf16 v20, v206, v14, v20
    v_add_f32_dpp v27, v27, v27 quad_perm:[1,0,3,2] row_mask:0xf bank_mask:0xf
    v_dot2_f32_bf16 v21, v210, v14, v21
    v_dot2_f32_bf16 v22, v214, v18, v22
    v_add_f32_dpp v27, v27, v27 quad_perm:[2,3,0,1] row_mask:0xf bank_mask:0xf
    v_dot2_f32_bf16 v20, v207, v15, v20
    v_dot2_f32_bf16 v21, v211, v15, v21
    v_add_f32_dpp v27, v27, v27 row_half_mirror row_mask:0xf bank_mask:0xf
    v_dot2_f32_bf16 v22, v215, v19, v22
    s_mov_b32 s44, 73728
    s_waitcnt vmcnt(23)
    buffer_load_dwordx4 v[204:207], v4, s[32:35], s44 offen nt
    s_waitcnt vmcnt(23)
    buffer_load_dwordx4 v[208:211], v4, s[32:35], s44 offen offset:384 nt
    s_waitcnt vmcnt(23)
    buffer_load_dwordx4 v[212:215], v5, s[32:35], s44 offen nt
    s_waitcnt vmcnt(39)
    v_cvt_pk_bf16_f32 v31, v26, v27
    v_lshlrev_b32 v28, 16, v31
    v_and_b32 v29, 0xffff0000, v31
    v_pk_mul_f32 v[28:29], v[28:29], s[48:49]
    v_cvt_pk_bf16_f32 v31, v28, v29
    v_lshlrev_b32 v60, 16, v31
    v_and_b32 v61, 0xffff0000, v31
    v_max3_f32 v30, v30, v60, v61
    v_dot2_f32_bf16 v23, v216, v12, 0
    v_add_f32_dpp v26, v20, v20 row_ror:8 row_mask:0xf bank_mask:0xf
    v_dot2_f32_bf16 v24, v220, v12, 0
    v_dot2_f32_bf16 v25, v224, v16, 0
    v_add_f32_dpp v26, v21, v21 row_ror:8 row_mask:0xf bank_mask:0xc
    v_dot2_f32_bf16 v23, v217, v13, v23
    v_dot2_f32_bf16 v24, v221, v13, v24
    v_add_f32 v26, v26, v22
    v_dot2_f32_bf16 v25, v225, v17, v25
    v_dot2_f32_bf16 v23, v218, v14, v23
    v_add_f32_dpp v26, v26, v26 quad_perm:[1,0,3,2] row_mask:0xf bank_mask:0xf
    v_dot2_f32_bf16 v24, v222, v14, v24
    v_dot2_f32_bf16 v25, v226, v18, v25
    v_add_f32_dpp v26, v26, v26 quad_perm:[2,3,0,1] row_mask:0xf bank_mask:0xf
    v_dot2_f32_bf16 v23, v219, v15, v23
    v_dot2_f32_bf16 v24, v223, v15, v24
    v_add_f32_dpp v26, v26, v26 row_half_mirror row_mask:0xf bank_mask:0xf
    v_dot2_f32_bf16 v25, v227, v19, v25
    s_mov_b32 s44, 76800
    s_waitcnt vmcnt(23)
    buffer_load_dwordx4 v[216:219], v4, s[32:35], s44 offen nt
    s_waitcnt vmcnt(23)
    buffer_load_dwordx4 v[220:223], v4, s[32:35], s44 offen offset:384 nt
    s_waitcnt vmcnt(23)
    buffer_load_dwordx4 v[224:227], v5, s[32:35], s44 offen nt
    s_waitcnt vmcnt(39)
    v_dot2_f32_bf16 v20, v228, v12, 0
    v_add_f32_dpp v27, v23, v23 row_ror:8 row_mask:0xf bank_mask:0xf
    v_dot2_f32_bf16 v21, v232, v12, 0
    v_dot2_f32_bf16 v22, v236, v16, 0
    v_add_f32_dpp v27, v24, v24 row_ror:8 row_mask:0xf bank_mask:0xc
    v_dot2_f32_bf16 v20, v229, v13, v20
    v_dot2_f32_bf16 v21, v233, v13, v21
    v_add_f32 v27, v27, v25
    v_dot2_f32_bf16 v22, v237, v17, v22
    v_dot2_f32_bf16 v20, v230, v14, v20
    v_add_f32_dpp v27, v27, v27 quad_perm:[1,0,3,2] row_mask:0xf bank_mask:0xf
    v_dot2_f32_bf16 v21, v234, v14, v21
    v_dot2_f32_bf16 v22, v238, v18, v22
    v_add_f32_dpp v27, v27, v27 quad_perm:[2,3,0,1] row_mask:0xf bank_mask:0xf
    v_dot2_f32_bf16 v20, v231, v15, v20
    v_dot2_f32_bf16 v21, v235, v15, v21
    v_add_f32_dpp v27, v27, v27 row_half_mirror row_mask:0xf bank_mask:0xf
    v_dot2_f32_bf16 v22, v239, v19, v22
    s_mov_b32 s44, 79872
    s_waitcnt vmcnt(23)
    buffer_load_dwordx4 v[228:231], v4, s[32:35], s44 offen nt
    s_waitcnt vmcnt(23)
    buffer_load_dwordx4 v[232:235], v4, s[32:35], s44 offen offset:384 nt
    s_waitcnt vmcnt(23)
    buffer_load_dwordx4 v[236:239], v5, s[32:35], s44 offen nt
    s_waitcnt vmcnt(39)
    v_cvt_pk_bf16_f32 v31, v26, v27
    v_lshlrev_b32 v28, 16, v31
    v_and_b32 v29, 0xffff0000, v31
    v_pk_mul_f32 v[28:29], v[28:29], s[48:49]
    v_cvt_pk_bf16_f32 v31, v28, v29
    v_lshlrev_b32 v62, 16, v31
    v_and_b32 v63, 0xffff0000, v31
    v_max3_f32 v30, v30, v62, v63
    v_dot2_f32_bf16 v23, v240, v12, 0
    v_add_f32_dpp v26, v20, v20 row_ror:8 row_mask:0xf bank_mask:0xf
    v_dot2_f32_bf16 v24, v244, v12, 0
    v_dot2_f32_bf16 v25, v248, v16, 0
    v_add_f32_dpp v26, v21, v21 row_ror:8 row_mask:0xf bank_mask:0xc
    v_dot2_f32_bf16 v23, v241, v13, v23
    v_dot2_f32_bf16 v24, v245, v13, v24
    v_add_f32 v26, v26, v22
    v_dot2_f32_bf16 v25, v249, v17, v25
    v_dot2_f32_bf16 v23, v242, v14, v23
    v_add_f32_dpp v26, v26, v26 quad_perm:[1,0,3,2] row_mask:0xf bank_mask:0xf
    v_dot2_f32_bf16 v24, v246, v14, v24
    v_dot2_f32_bf16 v25, v250, v18, v25
    v_add_f32_dpp v26, v26, v26 quad_perm:[2,3,0,1] row_mask:0xf bank_mask:0xf
    v_dot2_f32_bf16 v23, v243, v15, v23
    v_dot2_f32_bf16 v24, v247, v15, v24
    v_add_f32_dpp v26, v26, v26 row_half_mirror row_mask:0xf bank_mask:0xf
    v_dot2_f32_bf16 v25, v251, v19, v25
    s_mov_b32 s44, 82944
    s_waitcnt vmcnt(23)
    buffer_load_dwordx4 v[240:243], v4, s[32:35], s44 offen nt
    s_waitcnt vmcnt(23)
    buffer_load_dwordx4 v[244:247], v4, s[32:35], s44 offen offset:384 nt
    s_waitcnt vmcnt(23)
    buffer_load_dwordx4 v[248:251], v5, s[32:35], s44 offen nt
    s_waitcnt vmcnt(39)
    v_dot2_f32_bf16 v20, v84, v12, 0
    v_add_f32_dpp v27, v23, v23 row_ror:8 row_mask:0xf bank_mask:0xf
    v_dot2_f32_bf16 v21, v88, v12, 0
    v_dot2_f32_bf16 v22, v92, v16, 0
    v_add_f32_dpp v27, v24, v24 row_ror:8 row_mask:0xf bank_mask:0xc
    v_dot2_f32_bf16 v20, v85, v13, v20
    v_dot2_f32_bf16 v21, v89, v13, v21
    v_add_f32 v27, v27, v25
    v_dot2_f32_bf16 v22, v93, v17, v22
    v_dot2_f32_bf16 v20, v86, v14, v20
    v_add_f32_dpp v27, v27, v27 quad_perm:[1,0,3,2] row_mask:0xf bank_mask:0xf
    v_dot2_f32_bf16 v21, v90, v14, v21
    v_dot2_f32_bf16 v22, v94, v18, v22
    v_add_f32_dpp v27, v27, v27 quad_perm:[2,3,0,1] row_mask:0xf bank_mask:0xf
    v_dot2_f32_bf16 v20, v87, v15, v20
    v_dot2_f32_bf16 v21, v91, v15, v21
    v_add_f32_dpp v27, v27, v27 row_half_mirror row_mask:0xf bank_mask:0xf
    v_dot2_f32_bf16 v22, v95, v19, v22
    s_mov_b32 s44, 86016
    s_waitcnt vmcnt(23)
    buffer_load_dwordx4 v[84:87], v4, s[32:35], s44 offen nt
    s_waitcnt vmcnt(23)
    buffer_load_dwordx4 v[88:91], v4, s[32:35], s44 offen offset:384 nt
    s_waitcnt vmcnt(23)
    buffer_load_dwordx4 v[92:95], v5, s[32:35], s44 offen nt
    s_waitcnt vmcnt(39)
    v_cvt_pk_bf16_f32 v31, v26, v27
    v_lshlrev_b32 v28, 16, v31
    v_and_b32 v29, 0xffff0000, v31
    v_pk_mul_f32 v[28:29], v[28:29], s[48:49]
    v_cvt_pk_bf16_f32 v31, v28, v29
    v_lshlrev_b32 v64, 16, v31
    v_and_b32 v65, 0xffff0000, v31
    v_max3_f32 v30, v30, v64, v65
    v_dot2_f32_bf16 v23, v96, v12, 0
    v_add_f32_dpp v26, v20, v20 row_ror:8 row_mask:0xf bank_mask:0xf
    v_dot2_f32_bf16 v24, v100, v12, 0
    v_dot2_f32_bf16 v25, v104, v16, 0
    v_add_f32_dpp v26, v21, v21 row_ror:8 row_mask:0xf bank_mask:0xc
    v_dot2_f32_bf16 v23, v97, v13, v23
    v_dot2_f32_bf16 v24, v101, v13, v24
    v_add_f32 v26, v26, v22
    v_dot2_f32_bf16 v25, v105, v17, v25
    v_dot2_f32_bf16 v23, v98, v14, v23
    v_add_f32_dpp v26, v26, v26 quad_perm:[1,0,3,2] row_mask:0xf bank_mask:0xf
    v_dot2_f32_bf16 v24, v102, v14, v24
    v_dot2_f32_bf16 v25, v106, v18, v25
    v_add_f32_dpp v26, v26, v26 quad_perm:[2,3,0,1] row_mask:0xf bank_mask:0xf
    v_dot2_f32_bf16 v23, v99, v15, v23
    v_dot2_f32_bf16 v24, v103, v15, v24
    v_add_f32_dpp v26, v26, v26 row_half_mirror row_mask:0xf bank_mask:0xf
    v_dot2_f32_bf16 v25, v107, v19, v25
    s_mov_b32 s44, 89088
    s_waitcnt vmcnt(23)
    buffer_load_dwordx4 v[96:99], v4, s[32:35], s44 offen nt
    s_waitcnt vmcnt(23)
    buffer_load_dwordx4 v[100:103], v4, s[32:35], s44 offen offset:384 nt
    s_waitcnt vmcnt(23)
    buffer_load_dwordx4 v[104:107], v5, s[32:35], s44 offen nt
    s_waitcnt vmcnt(39)
    v_dot2_f32_bf16 v20, v108, v12, 0
    v_add_f32_dpp v27, v23, v23 row_ror:8 row_mask:0xf bank_mask:0xf
    v_dot2_f32_bf16 v21, v112, v12, 0
    v_dot2_f32_bf16 v22, v116, v16, 0
    v_add_f32_dpp v27, v24, v24 row_ror:8 row_mask:0xf bank_mask:0xc
    v_dot2_f32_bf16 v20, v109, v13, v20
    v_dot2_f32_bf16 v21, v113, v13, v21
    v_add_f32 v27, v27, v25
    v_dot2_f32_bf16 v22, v117, v17, v22
    v_dot2_f32_bf16 v20, v110, v14, v20
    v_add_f32_dpp v27, v27, v27 quad_perm:[1,0,3,2] row_mask:0xf bank_mask:0xf
    v_dot2_f32_bf16 v21, v114, v14, v21
    v_dot2_f32_bf16 v22, v118, v18, v22
    v_add_f32_dpp v27, v27, v27 quad_perm:[2,3,0,1] row_mask:0xf bank_mask:0xf
    v_dot2_f32_bf16 v20, v111, v15, v20
    v_dot2_f32_bf16 v21, v115, v15, v21
    v_add_f32_dpp v27, v27, v27 row_half_mirror row_mask:0xf bank_mask:0xf
    v_dot2_f32_bf16 v22, v119, v19, v22
    s_mov_b32 s44, 92160
    s_waitcnt vmcnt(23)
    buffer_load_dwordx4 v[108:111], v4, s[32:35], s44 offen nt
    s_waitcnt vmcnt(23)
    buffer_load_dwordx4 v[112:115], v4, s[32:35], s44 offen offset:384 nt
    s_waitcnt vmcnt(23)
    buffer_load_dwordx4 v[116:119], v5, s[32:35], s44 offen nt
    s_waitcnt vmcnt(39)
    v_cvt_pk_bf16_f32 v31, v26, v27
    v_lshlrev_b32 v28, 16, v31
    v_and_b32 v29, 0xffff0000, v31
    v_pk_mul_f32 v[28:29], v[28:29], s[48:49]
    v_cvt_pk_bf16_f32 v31, v28, v29
    v_lshlrev_b32 v66, 16, v31
    v_and_b32 v67, 0xffff0000, v31
    v_max3_f32 v30, v30, v66, v67
    v_dot2_f32_bf16 v23, v120, v12, 0
    v_add_f32_dpp v26, v20, v20 row_ror:8 row_mask:0xf bank_mask:0xf
    v_dot2_f32_bf16 v24, v124, v12, 0
    v_dot2_f32_bf16 v25, v128, v16, 0
    v_add_f32_dpp v26, v21, v21 row_ror:8 row_mask:0xf bank_mask:0xc
    v_dot2_f32_bf16 v23, v121, v13, v23
    v_dot2_f32_bf16 v24, v125, v13, v24
    v_add_f32 v26, v26, v22
    v_dot2_f32_bf16 v25, v129, v17, v25
    v_dot2_f32_bf16 v23, v122, v14, v23
    v_add_f32_dpp v26, v26, v26 quad_perm:[1,0,3,2] row_mask:0xf bank_mask:0xf
    v_dot2_f32_bf16 v24, v126, v14, v24
    v_dot2_f32_bf16 v25, v130, v18, v25
    v_add_f32_dpp v26, v26, v26 quad_perm:[2,3,0,1] row_mask:0xf bank_mask:0xf
    v_dot2_f32_bf16 v23, v123, v15, v23
    v_dot2_f32_bf16 v24, v127, v15, v24
    v_add_f32_dpp v26, v26, v26 row_half_mirror row_mask:0xf bank_mask:0xf
    v_dot2_f32_bf16 v25, v131, v19, v25
    s_mov_b32 s44, 95232
    s_waitcnt vmcnt(23)
    buffer_load_dwordx4 v[120:123], v4, s[32:35], s44 offen nt
    s_waitcnt vmcnt(23)
    buffer_load_dwordx4 v[124:127], v4, s[32:35], s44 offen offset:384 nt
    s_waitcnt vmcnt(23)
    buffer_load_dwordx4 v[128:131], v5, s[32:35], s44 offen nt
    s_waitcnt vmcnt(39)
    v_dot2_f32_bf16 v20, v132, v12, 0
    v_add_f32_dpp v27, v23, v23 row_ror:8 row_mask:0xf bank_mask:0xf
    v_dot2_f32_bf16 v21, v136, v12, 0
    v_dot2_f32_bf16 v22, v140, v16, 0
    v_add_f32_dpp v27, v24, v24 row_ror:8 row_mask:0xf bank_mask:0xc
    v_dot2_f32_bf16 v20, v133, v13, v20
    v_dot2_f32_bf16 v21, v137, v13, v21
    v_add_f32 v27, v27, v25
    v_dot2_f32_bf16 v22, v141, v17, v22
    v_dot2_f32_bf16 v20, v134, v14, v20
    v_add_f32_dpp v27, v27, v27 quad_perm:[1,0,3,2] row_mask:0xf bank_mask:0xf
    v_dot2_f32_bf16 v21, v138, v14, v21
    v_dot2_f32_bf16 v22, v142, v18, v22
    v_add_f32_dpp v27, v27, v27 quad_perm:[2,3,0,1] row_mask:0xf bank_mask:0xf
    v_dot2_f32_bf16 v20, v135, v15, v20
    v_dot2_f32_bf16 v21, v139, v15, v21
    v_add_f32_dpp v27, v27, v27 row_half_mirror row_mask:0xf bank_mask:0xf
    v_dot2_f32_bf16 v22, v143, v19, v22
    s_mov_b32 s44, 0
    s_waitcnt vmcnt(23)
    buffer_load_dwordx4 v[132:135], v4, s[36:39], s44 offen nt
    s_waitcnt vmcnt(23)
    buffer_load_dwordx4 v[136:139], v4, s[36:39], s44 offen offset:384 nt
    s_waitcnt vmcnt(23)
    buffer_load_dwordx4 v[140:143], v5, s[36:39], s44 offen nt
    s_waitcnt vmcnt(39)
    v_cvt_pk_bf16_f32 v31, v26, v27
    v_lshlrev_b32 v28, 16, v31
    v_and_b32 v29, 0xffff0000, v31
    v_pk_mul_f32 v[28:29], v[28:29], s[48:49]
    v_cvt_pk_bf16_f32 v31, v28, v29
    v_lshlrev_b32 v68, 16, v31
    v_and_b32 v69, 0xffff0000, v31
    v_max3_f32 v30, v30, v68, v69
    v_dot2_f32_bf16 v23, v144, v12, 0
    v_add_f32_dpp v26, v20, v20 row_ror:8 row_mask:0xf bank_mask:0xf
    v_dot2_f32_bf16 v24, v148, v12, 0
    v_dot2_f32_bf16 v25, v152, v16, 0
    v_add_f32_dpp v26, v21, v21 row_ror:8 row_mask:0xf bank_mask:0xc
    v_dot2_f32_bf16 v23, v145, v13, v23
    v_dot2_f32_bf16 v24, v149, v13, v24
    v_add_f32 v26, v26, v22
    v_dot2_f32_bf16 v25, v153, v17, v25
    v_dot2_f32_bf16 v23, v146, v14, v23
    v_add_f32_dpp v26, v26, v26 quad_perm:[1,0,3,2] row_mask:0xf bank_mask:0xf
    v_dot2_f32_bf16 v24, v150, v14, v24
    v_dot2_f32_bf16 v25, v154, v18, v25
    v_add_f32_dpp v26, v26, v26 quad_perm:[2,3,0,1] row_mask:0xf bank_mask:0xf
    v_dot2_f32_bf16 v23, v147, v15, v23
    v_dot2_f32_bf16 v24, v151, v15, v24
    v_add_f32_dpp v26, v26, v26 row_half_mirror row_mask:0xf bank_mask:0xf
    v_dot2_f32_bf16 v25, v155, v19, v25
    s_mov_b32 s44, 3072
    s_waitcnt vmcnt(23)
    buffer_load_dwordx4 v[144:147], v4, s[36:39], s44 offen nt
    s_waitcnt vmcnt(23)
    buffer_load_dwordx4 v[148:151], v4, s[36:39], s44 offen offset:384 nt
    s_waitcnt vmcnt(23)
    buffer_load_dwordx4 v[152:155], v5, s[36:39], s44 offen nt
    s_waitcnt vmcnt(39)
    v_dot2_f32_bf16 v20, v156, v12, 0
    v_add_f32_dpp v27, v23, v23 row_ror:8 row_mask:0xf bank_mask:0xf
    v_dot2_f32_bf16 v21, v160, v12, 0
    v_dot2_f32_bf16 v22, v164, v16, 0
    v_add_f32_dpp v27, v24, v24 row_ror:8 row_mask:0xf bank_mask:0xc
    v_dot2_f32_bf16 v20, v157, v13, v20
    v_dot2_f32_bf16 v21, v161, v13, v21
    v_add_f32 v27, v27, v25
    v_dot2_f32_bf16 v22, v165, v17, v22
    v_dot2_f32_bf16 v20, v158, v14, v20
    v_add_f32_dpp v27, v27, v27 quad_perm:[1,0,3,2] row_mask:0xf bank_mask:0xf
    v_dot2_f32_bf16 v21, v162, v14, v21
    v_dot2_f32_bf16 v22, v166, v18, v22
    v_add_f32_dpp v27, v27, v27 quad_perm:[2,3,0,1] row_mask:0xf bank_mask:0xf
    v_dot2_f32_bf16 v20, v159, v15, v20
    v_dot2_f32_bf16 v21, v163, v15, v21
    v_add_f32_dpp v27, v27, v27 row_half_mirror row_mask:0xf bank_mask:0xf
    v_dot2_f32_bf16 v22, v167, v19, v22
    s_mov_b32 s44, 6144
    s_waitcnt vmcnt(23)
    buffer_load_dwordx4 v[156:159], v4, s[36:39], s44 offen nt
    s_waitcnt vmcnt(23)
    buffer_load_dwordx4 v[160:163], v4, s[36:39], s44 offen offset:384 nt
    s_waitcnt vmcnt(23)
    buffer_load_dwordx4 v[164:167], v5, s[36:39], s44 offen nt
    s_waitcnt vmcnt(39)
    v_cvt_pk_bf16_f32 v31, v26, v27
    v_lshlrev_b32 v28, 16, v31
    v_and_b32 v29, 0xffff0000, v31
    v_pk_mul_f32 v[28:29], v[28:29], s[48:49]
    v_cvt_pk_bf16_f32 v31, v28, v29
    v_lshlrev_b32 v70, 16, v31
    v_and_b32 v71, 0xffff0000, v31
    v_max3_f32 v30, v30, v70, v71
    v_dot2_f32_bf16 v23, v168, v12, 0
    v_add_f32_dpp v26, v20, v20 row_ror:8 row_mask:0xf bank_mask:0xf
    v_dot2_f32_bf16 v24, v172, v12, 0
    v_dot2_f32_bf16 v25, v176, v16, 0
    v_add_f32_dpp v26, v21, v21 row_ror:8 row_mask:0xf bank_mask:0xc
    v_dot2_f32_bf16 v23, v169, v13, v23
    v_dot2_f32_bf16 v24, v173, v13, v24
    v_add_f32 v26, v26, v22
    v_dot2_f32_bf16 v25, v177, v17, v25
    v_dot2_f32_bf16 v23, v170, v14, v23
    v_add_f32_dpp v26, v26, v26 quad_perm:[1,0,3,2] row_mask:0xf bank_mask:0xf
    v_dot2_f32_bf16 v24, v174, v14, v24
    v_dot2_f32_bf16 v25, v178, v18, v25
    v_add_f32_dpp v26, v26, v26 quad_perm:[2,3,0,1] row_mask:0xf bank_mask:0xf
    v_dot2_f32_bf16 v23, v171, v15, v23
    v_dot2_f32_bf16 v24, v175, v15, v24
    v_add_f32_dpp v26, v26, v26 row_half_mirror row_mask:0xf bank_mask:0xf
    v_dot2_f32_bf16 v25, v179, v19, v25
    s_mov_b32 s44, 9216
    s_waitcnt vmcnt(23)
    buffer_load_dwordx4 v[168:171], v4, s[36:39], s44 offen nt
    s_waitcnt vmcnt(23)
    buffer_load_dwordx4 v[172:175], v4, s[36:39], s44 offen offset:384 nt
    s_waitcnt vmcnt(23)
    buffer_load_dwordx4 v[176:179], v5, s[36:39], s44 offen nt
    s_waitcnt vmcnt(39)
    v_dot2_f32_bf16 v20, v180, v12, 0
    v_add_f32_dpp v27, v23, v23 row_ror:8 row_mask:0xf bank_mask:0xf
    v_dot2_f32_bf16 v21, v184, v12, 0
    v_dot2_f32_bf16 v22, v188, v16, 0
    v_add_f32_dpp v27, v24, v24 row_ror:8 row_mask:0xf bank_mask:0xc
    v_dot2_f32_bf16 v20, v181, v13, v20
    v_dot2_f32_bf16 v21, v185, v13, v21
    v_add_f32 v27, v27, v25
    v_dot2_f32_bf16 v22, v189, v17, v22
    v_dot2_f32_bf16 v20, v182, v14, v20
    v_add_f32_dpp v27, v27, v27 quad_perm:[1,0,3,2] row_mask:0xf bank_mask:0xf
    v_dot2_f32_bf16 v21, v186, v14, v21
    v_dot2_f32_bf16 v22, v190, v18, v22
    v_add_f32_dpp v27, v27, v27 quad_perm:[2,3,0,1] row_mask:0xf bank_mask:0xf
    v_dot2_f32_bf16 v20, v183, v15, v20
    v_dot2_f32_bf16 v21, v187, v15, v21
    v_add_f32_dpp v27, v27, v27 row_half_mirror row_mask:0xf bank_mask:0xf
    v_dot2_f32_bf16 v22, v191, v19, v22
    s_mov_b32 s44, 12288
    s_waitcnt vmcnt(23)
    buffer_load_dwordx4 v[180:183], v4, s[36:39], s44 offen nt
    s_waitcnt vmcnt(23)
    buffer_load_dwordx4 v[184:187], v4, s[36:39], s44 offen offset:384 nt
    s_waitcnt vmcnt(23)
    buffer_load_dwordx4 v[188:191], v5, s[36:39], s44 offen nt
    s_waitcnt vmcnt(39)
    v_cvt_pk_bf16_f32 v31, v26, v27
    v_lshlrev_b32 v28, 16, v31
    v_and_b32 v29, 0xffff0000, v31
    v_pk_mul_f32 v[28:29], v[28:29], s[48:49]
    v_cvt_pk_bf16_f32 v31, v28, v29
    v_lshlrev_b32 v72, 16, v31
    v_and_b32 v73, 0xffff0000, v31
    v_max3_f32 v30, v30, v72, v73
    v_dot2_f32_bf16 v23, v192, v12, 0
    v_add_f32_dpp v26, v20, v20 row_ror:8 row_mask:0xf bank_mask:0xf
    v_dot2_f32_bf16 v24, v196, v12, 0
    v_dot2_f32_bf16 v25, v200, v16, 0
    v_add_f32_dpp v26, v21, v21 row_ror:8 row_mask:0xf bank_mask:0xc
    v_dot2_f32_bf16 v23, v193, v13, v23
    v_dot2_f32_bf16 v24, v197, v13, v24
    v_add_f32 v26, v26, v22
    v_dot2_f32_bf16 v25, v201, v17, v25
    v_dot2_f32_bf16 v23, v194, v14, v23
    v_add_f32_dpp v26, v26, v26 quad_perm:[1,0,3,2] row_mask:0xf bank_mask:0xf
    v_dot2_f32_bf16 v24, v198, v14, v24
    v_dot2_f32_bf16 v25, v202, v18, v25
    v_add_f32_dpp v26, v26, v26 quad_perm:[2,3,0,1] row_mask:0xf bank_mask:0xf
    v_dot2_f32_bf16 v23, v195, v15, v23
    v_dot2_f32_bf16 v24, v199, v15, v24
    v_add_f32_dpp v26, v26, v26 row_half_mirror row_mask:0xf bank_mask:0xf
    v_dot2_f32_bf16 v25, v203, v19, v25
    s_mov_b32 s44, 15360
    s_waitcnt vmcnt(23)
    buffer_load_dwordx4 v[192:195], v4, s[36:39], s44 offen nt
    s_waitcnt vmcnt(23)
    buffer_load_dwordx4 v[196:199], v4, s[36:39], s44 offen offset:384 nt
    s_waitcnt vmcnt(23)
    buffer_load_dwordx4 v[200:203], v5, s[36:39], s44 offen nt
    s_waitcnt vmcnt(39)
    v_dot2_f32_bf16 v20, v204, v12, 0
    v_add_f32_dpp v27, v23, v23 row_ror:8 row_mask:0xf bank_mask:0xf
    v_dot2_f32_bf16 v21, v208, v12, 0
    v_dot2_f32_bf16 v22, v212, v16, 0
    v_add_f32_dpp v27, v24, v24 row_ror:8 row_mask:0xf bank_mask:0xc
    v_dot2_f32_bf16 v20, v205, v13, v20
    v_dot2_f32_bf16 v21, v209, v13, v21
    v_add_f32 v27, v27, v25
    v_dot2_f32_bf16 v22, v213, v17, v22
    v_dot2_f32_bf16 v20, v206, v14, v20
    v_add_f32_dpp v27, v27, v27 quad_perm:[1,0,3,2] row_mask:0xf bank_mask:0xf
    v_dot2_f32_bf16 v21, v210, v14, v21
    v_dot2_f32_bf16 v22, v214, v18, v22
    v_add_f32_dpp v27, v27, v27 quad_perm:[2,3,0,1] row_mask:0xf bank_mask:0xf
    v_dot2_f32_bf16 v20, v207, v15, v20
    v_dot2_f32_bf16 v21, v211, v15, v21
    v_add_f32_dpp v27, v27, v27 row_half_mirror row_mask:0xf bank_mask:0xf
    v_dot2_f32_bf16 v22, v215, v19, v22
    s_mov_b32 s44, 18432
    s_waitcnt vmcnt(23)
    buffer_load_dwordx4 v[204:207], v4, s[36:39], s44 offen nt
    s_waitcnt vmcnt(23)
    buffer_load_dwordx4 v[208:211], v4, s[36:39], s44 offen offset:384 nt
    s_waitcnt vmcnt(23)
    buffer_load_dwordx4 v[212:215], v5, s[36:39], s44 offen nt
    s_waitcnt vmcnt(39)
    v_cvt_pk_bf16_f32 v31, v26, v27
    v_lshlrev_b32 v28, 16, v31
    v_and_b32 v29, 0xffff0000, v31
    v_pk_mul_f32 v[28:29], v[28:29], s[48:49]
    v_cvt_pk_bf16_f32 v31, v28, v29
    v_lshlrev_b32 v74, 16, v31
    v_and_b32 v75, 0xffff0000, v31
    v_max3_f32 v30, v30, v74, v75
    v_dot2_f32_bf16 v23, v216, v12, 0
    v_add_f32_dpp v26, v20, v20 row_ror:8 row_mask:0xf bank_mask:0xf
    v_dot2_f32_bf16 v24, v220, v12, 0
    v_dot2_f32_bf16 v25, v224, v16, 0
    v_add_f32_dpp v26, v21, v21 row_ror:8 row_mask:0xf bank_mask:0xc
    v_dot2_f32_bf16 v23, v217, v13, v23
    v_dot2_f32_bf16 v24, v221, v13, v24
    v_add_f32 v26, v26, v22
    v_dot2_f32_bf16 v25, v225, v17, v25
    v_dot2_f32_bf16 v23, v218, v14, v23
    v_add_f32_dpp v26, v26, v26 quad_perm:[1,0,3,2] row_mask:0xf bank_mask:0xf
    v_dot2_f32_bf16 v24, v222, v14, v24
    v_dot2_f32_bf16 v25, v226, v18, v25
    v_add_f32_dpp v26, v26, v26 quad_perm:[2,3,0,1] row_mask:0xf bank_mask:0xf
    v_dot2_f32_bf16 v23, v219, v15, v23
    v_dot2_f32_bf16 v24, v223, v15, v24
    v_add_f32_dpp v26, v26, v26 row_half_mirror row_mask:0xf bank_mask:0xf
    v_dot2_f32_bf16 v25, v227, v19, v25
    s_mov_b32 s44, 21504
    s_waitcnt vmcnt(23)
    buffer_load_dwordx4 v[216:219], v4, s[36:39], s44 offen nt
    s_waitcnt vmcnt(23)
    buffer_load_dwordx4 v[220:223], v4, s[36:39], s44 offen offset:384 nt
    s_waitcnt vmcnt(23)
    buffer_load_dwordx4 v[224:227], v5, s[36:39], s44 offen nt
    s_waitcnt vmcnt(39)
    v_dot2_f32_bf16 v20, v228, v12, 0
    v_add_f32_dpp v27, v23, v23 row_ror:8 row_mask:0xf bank_mask:0xf
    v_dot2_f32_bf16 v21, v232, v12, 0
    v_dot2_f32_bf16 v22, v236, v16, 0
    v_add_f32_dpp v27, v24, v24 row_ror:8 row_mask:0xf bank_mask:0xc
    v_dot2_f32_bf16 v20, v229, v13, v20
    v_dot2_f32_bf16 v21, v233, v13, v21
    v_add_f32 v27, v27, v25
    v_dot2_f32_bf16 v22, v237, v17, v22
    v_dot2_f32_bf16 v20, v230, v14, v20
    v_add_f32_dpp v27, v27, v27 quad_perm:[1,0,3,2] row_mask:0xf bank_mask:0xf
    v_dot2_f32_bf16 v21, v234, v14, v21
    v_dot2_f32_bf16 v22, v238, v18, v22
    v_add_f32_dpp v27, v27, v27 quad_perm:[2,3,0,1] row_mask:0xf bank_mask:0xf
    v_dot2_f32_bf16 v20, v231, v15, v20
    v_dot2_f32_bf16 v21, v235, v15, v21
    v_add_f32_dpp v27, v27, v27 row_half_mirror row_mask:0xf bank_mask:0xf
    v_dot2_f32_bf16 v22, v239, v19, v22
    s_mov_b32 s44, 24576
    s_waitcnt vmcnt(23)
    buffer_load_dwordx4 v[228:231], v4, s[36:39], s44 offen nt
    s_waitcnt vmcnt(23)
    buffer_load_dwordx4 v[232:235], v4, s[36:39], s44 offen offset:384 nt
    s_waitcnt vmcnt(23)
    buffer_load_dwordx4 v[236:239], v5, s[36:39], s44 offen nt
    s_waitcnt vmcnt(39)
    v_cvt_pk_bf16_f32 v31, v26, v27
    v_lshlrev_b32 v28, 16, v31
    v_and_b32 v29, 0xffff0000, v31
    v_pk_mul_f32 v[28:29], v[28:29], s[48:49]
    v_cvt_pk_bf16_f32 v31, v28, v29
    v_lshlrev_b32 v76, 16, v31
    v_and_b32 v77, 0xffff0000, v31
    v_max3_f32 v30, v30, v76, v77
    v_dot2_f32_bf16 v23, v240, v12, 0
    v_add_f32_dpp v26, v20, v20 row_ror:8 row_mask:0xf bank_mask:0xf
    v_dot2_f32_bf16 v24, v244, v12, 0
    v_dot2_f32_bf16 v25, v248, v16, 0
    v_add_f32_dpp v26, v21, v21 row_ror:8 row_mask:0xf bank_mask:0xc
    v_dot2_f32_bf16 v23, v241, v13, v23
    v_dot2_f32_bf16 v24, v245, v13, v24
    v_add_f32 v26, v26, v22
    v_dot2_f32_bf16 v25, v249, v17, v25
    v_dot2_f32_bf16 v23, v242, v14, v23
    v_add_f32_dpp v26, v26, v26 quad_perm:[1,0,3,2] row_mask:0xf bank_mask:0xf
    v_dot2_f32_bf16 v24, v246, v14, v24
    v_dot2_f32_bf16 v25, v250, v18, v25
    v_add_f32_dpp v26, v26, v26 quad_perm:[2,3,0,1] row_mask:0xf bank_mask:0xf
    v_dot2_f32_bf16 v23, v243, v15, v23
    v_dot2_f32_bf16 v24, v247, v15, v24
    v_add_f32_dpp v26, v26, v26 row_half_mirror row_mask:0xf bank_mask:0xf
    v_dot2_f32_bf16 v25, v251, v19, v25
    s_mov_b32 s44, 27648
    s_waitcnt vmcnt(23)
    buffer_load_dwordx4 v[240:243], v4, s[36:39], s44 offen nt
    s_waitcnt vmcnt(23)
    buffer_load_dwordx4 v[244:247], v4, s[36:39], s44 offen offset:384 nt
    s_waitcnt vmcnt(23)
    buffer_load_dwordx4 v[248:251], v5, s[36:39], s44 offen nt
    s_waitcnt vmcnt(39)
    v_dot2_f32_bf16 v20, v84, v12, 0
    v_add_f32_dpp v27, v23, v23 row_ror:8 row_mask:0xf bank_mask:0xf
    v_dot2_f32_bf16 v21, v88, v12, 0
    v_dot2_f32_bf16 v22, v92, v16, 0
    v_add_f32_dpp v27, v24, v24 row_ror:8 row_mask:0xf bank_mask:0xc
    v_dot2_f32_bf16 v20, v85, v13, v20
    v_dot2_f32_bf16 v21, v89, v13, v21
    v_add_f32 v27, v27, v25
    v_dot2_f32_bf16 v22, v93, v17, v22
    v_dot2_f32_bf16 v20, v86, v14, v20
    v_add_f32_dpp v27, v27, v27 quad_perm:[1,0,3,2] row_mask:0xf bank_mask:0xf
    v_dot2_f32_bf16 v21, v90, v14, v21
    v_dot2_f32_bf16 v22, v94, v18, v22
    v_add_f32_dpp v27, v27, v27 quad_perm:[2,3,0,1] row_mask:0xf bank_mask:0xf
    v_dot2_f32_bf16 v20, v87, v15, v20
    v_dot2_f32_bf16 v21, v91, v15, v21
    v_add_f32_dpp v27, v27, v27 row_half_mirror row_mask:0xf bank_mask:0xf
    v_dot2_f32_bf16 v22, v95, v19, v22
    s_mov_b32 s44, 30720
    s_waitcnt vmcnt(23)
    buffer_load_dwordx4 v[84:87], v4, s[36:39], s44 offen nt
    s_waitcnt vmcnt(23)
    buffer_load_dwordx4 v[88:91], v4, s[36:39], s44 offen offset:384 nt
    s_waitcnt vmcnt(23)
    buffer_load_dwordx4 v[92:95], v5, s[36:39], s44 offen nt
    s_waitcnt vmcnt(39)
    v_cvt_pk_bf16_f32 v31, v26, v27
    v_lshlrev_b32 v28, 16, v31
    v_and_b32 v29, 0xffff0000, v31
    v_pk_mul_f32 v[28:29], v[28:29], s[48:49]
    v_cvt_pk_bf16_f32 v31, v28, v29
    v_lshlrev_b32 v78, 16, v31
    v_and_b32 v79, 0xffff0000, v31
    v_max3_f32 v30, v30, v78, v79
    v_dot2_f32_bf16 v23, v96, v12, 0
    v_add_f32_dpp v26, v20, v20 row_ror:8 row_mask:0xf bank_mask:0xf
    v_dot2_f32_bf16 v24, v100, v12, 0
    v_dot2_f32_bf16 v25, v104, v16, 0
    v_add_f32_dpp v26, v21, v21 row_ror:8 row_mask:0xf bank_mask:0xc
    v_dot2_f32_bf16 v23, v97, v13, v23
    v_dot2_f32_bf16 v24, v101, v13, v24
    v_add_f32 v26, v26, v22
    v_dot2_f32_bf16 v25, v105, v17, v25
    v_dot2_f32_bf16 v23, v98, v14, v23
    v_add_f32_dpp v26, v26, v26 quad_perm:[1,0,3,2] row_mask:0xf bank_mask:0xf
    v_dot2_f32_bf16 v24, v102, v14, v24
    v_dot2_f32_bf16 v25, v106, v18, v25
    v_add_f32_dpp v26, v26, v26 quad_perm:[2,3,0,1] row_mask:0xf bank_mask:0xf
    v_dot2_f32_bf16 v23, v99, v15, v23
    v_dot2_f32_bf16 v24, v103, v15, v24
    v_add_f32_dpp v26, v26, v26 row_half_mirror row_mask:0xf bank_mask:0xf
    v_dot2_f32_bf16 v25, v107, v19, v25
    s_mov_b32 s44, 33792
    s_waitcnt vmcnt(23)
    buffer_load_dwordx4 v[96:99], v4, s[36:39], s44 offen nt
    s_waitcnt vmcnt(23)
    buffer_load_dwordx4 v[100:103], v4, s[36:39], s44 offen offset:384 nt
    s_waitcnt vmcnt(23)
    buffer_load_dwordx4 v[104:107], v5, s[36:39], s44 offen nt
    s_waitcnt vmcnt(39)
    v_dot2_f32_bf16 v20, v108, v12, 0
    v_add_f32_dpp v27, v23, v23 row_ror:8 row_mask:0xf bank_mask:0xf
    v_dot2_f32_bf16 v21, v112, v12, 0
    v_dot2_f32_bf16 v22, v116, v16, 0
    v_add_f32_dpp v27, v24, v24 row_ror:8 row_mask:0xf bank_mask:0xc
    v_dot2_f32_bf16 v20, v109, v13, v20
    v_dot2_f32_bf16 v21, v113, v13, v21
    v_add_f32 v27, v27, v25
    v_dot2_f32_bf16 v22, v117, v17, v22
    v_dot2_f32_bf16 v20, v110, v14, v20
    v_add_f32_dpp v27, v27, v27 quad_perm:[1,0,3,2] row_mask:0xf bank_mask:0xf
    v_dot2_f32_bf16 v21, v114, v14, v21
    v_dot2_f32_bf16 v22, v118, v18, v22
    v_add_f32_dpp v27, v27, v27 quad_perm:[2,3,0,1] row_mask:0xf bank_mask:0xf
    v_dot2_f32_bf16 v20, v111, v15, v20
    v_dot2_f32_bf16 v21, v115, v15, v21
    v_add_f32_dpp v27, v27, v27 row_half_mirror row_mask:0xf bank_mask:0xf
    v_dot2_f32_bf16 v22, v119, v19, v22
    s_mov_b32 s44, 36864
    s_waitcnt vmcnt(23)
    buffer_load_dwordx4 v[108:111], v4, s[36:39], s44 offen nt
    s_waitcnt vmcnt(23)
    buffer_load_dwordx4 v[112:115], v4, s[36:39], s44 offen offset:384 nt
    s_waitcnt vmcnt(23)
    buffer_load_dwordx4 v[116:119], v5, s[36:39], s44 offen nt
    s_waitcnt vmcnt(39)
    v_cvt_pk_bf16_f32 v31, v26, v27
    v_lshlrev_b32 v28, 16, v31
    v_and_b32 v29, 0xffff0000, v31
    v_pk_mul_f32 v[28:29], v[28:29], s[48:49]
    v_cvt_pk_bf16_f32 v31, v28, v29
    v_lshlrev_b32 v80, 16, v31
    v_and_b32 v81, 0xffff0000, v31
    v_max3_f32 v30, v30, v80, v81
    v_dot2_f32_bf16 v23, v120, v12, 0
    v_add_f32_dpp v26, v20, v20 row_ror:8 row_mask:0xf bank_mask:0xf
    v_dot2_f32_bf16 v24, v124, v12, 0
    v_dot2_f32_bf16 v25, v128, v16, 0
    v_add_f32_dpp v26, v21, v21 row_ror:8 row_mask:0xf bank_mask:0xc
    v_dot2_f32_bf16 v23, v121, v13, v23
    v_dot2_f32_bf16 v24, v125, v13, v24
    v_add_f32 v26, v26, v22
    v_dot2_f32_bf16 v25, v129, v17, v25
    v_dot2_f32_bf16 v23, v122, v14, v23
    v_add_f32_dpp v26, v26, v26 quad_perm:[1,0,3,2] row_mask:0xf bank_mask:0xf
    v_dot2_f32_bf16 v24, v126, v14, v24
    v_dot2_f32_bf16 v25, v130, v18, v25
    v_add_f32_dpp v26, v26, v26 quad_perm:[2,3,0,1] row_mask:0xf bank_mask:0xf
    v_dot2_f32_bf16 v23, v123, v15, v23
    v_dot2_f32_bf16 v24, v127, v15, v24
    v_add_f32_dpp v26, v26, v26 row_half_mirror row_mask:0xf bank_mask:0xf
    v_dot2_f32_bf16 v25, v131, v19, v25
    s_mov_b32 s44, 39936
    s_waitcnt vmcnt(23)
    buffer_load_dwordx4 v[120:123], v4, s[36:39], s44 offen nt
    s_waitcnt vmcnt(23)
    buffer_load_dwordx4 v[124:127], v4, s[36:39], s44 offen offset:384 nt
    s_waitcnt vmcnt(23)
    buffer_load_dwordx4 v[128:131], v5, s[36:39], s44 offen nt
    v_add_f32_dpp v27, v23, v23 row_ror:8 row_mask:0xf bank_mask:0xf
    s_nop 1
    v_add_f32_dpp v27, v24, v24 row_ror:8 row_mask:0xf bank_mask:0xc
    v_add_f32 v27, v27, v25
    s_nop 1
    v_add_f32_dpp v27, v27, v27 quad_perm:[1,0,3,2] row_mask:0xf bank_mask:0xf
    s_nop 1
    v_add_f32_dpp v27, v27, v27 quad_perm:[2,3,0,1] row_mask:0xf bank_mask:0xf
    s_nop 1
    v_add_f32_dpp v27, v27, v27 row_half_mirror row_mask:0xf bank_mask:0xf
    v_cvt_pk_bf16_f32 v31, v26, v27
    v_lshlrev_b32 v28, 16, v31
    v_and_b32 v29, 0xffff0000, v31
    v_pk_mul_f32 v[28:29], v[28:29], s[48:49]
    v_cvt_pk_bf16_f32 v31, v28, v29
    v_lshlrev_b32 v82, 16, v31
    v_and_b32 v83, 0xffff0000, v31
    v_max3_f32 v30, v30, v82, v83
    s_nop 1
    v_max_f32_dpp v30, v30, v30 row_ror:8 row_mask:0xf bank_mask:0xf
    v_mov_b32 v31, v30
    s_nop 1
    v_permlane16_swap_b32 v30, v31
    v_max_f32 v30, v30, v31
    v_mov_b32 v31, v30
    s_nop 1
    v_permlane32_swap_b32 v30, v31
    v_max_f32 v30, v30, v31
    s_lshl_b32 s57, s59, 2
    v_mov_b32 v31, s57
    s_mov_b64 exec, 1
    ds_write_b32 v31, v30 offset:896
    s_mov_b64 exec, -1
    v_mov_b32 v31, 0
    s_waitcnt lgkmcnt(0)
    s_barrier
    ds_read_b128 v[20:23], v31 offset:896
    s_waitcnt lgkmcnt(0)
    v_max3_f32 v20, v20, v21, v22
    v_max_f32 v30, v20, v23
    v_sub_f32 v28, 0, v30
    v_pk_add_f32 v[52:53], v[52:53], v[28:29] op_sel_hi:[1,0]
    v_pk_add_f32 v[54:55], v[54:55], v[28:29] op_sel_hi:[1,0]
    v_pk_add_f32 v[56:57], v[56:57], v[28:29] op_sel_hi:[1,0]
    v_pk_add_f32 v[58:59], v[58:59], v[28:29] op_sel_hi:[1,0]
    v_pk_add_f32 v[60:61], v[60:61], v[28:29] op_sel_hi:[1,0]
    v_pk_add_f32 v[62:63], v[62:63], v[28:29] op_sel_hi:[1,0]
    v_pk_add_f32 v[64:65], v[64:65], v[28:29] op_sel_hi:[1,0]
    v_pk_add_f32 v[66:67], v[66:67], v[28:29] op_sel_hi:[1,0]
    v_pk_add_f32 v[68:69], v[68:69], v[28:29] op_sel_hi:[1,0]
    v_pk_add_f32 v[70:71], v[70:71], v[28:29] op_sel_hi:[1,0]
    v_pk_add_f32 v[72:73], v[72:73], v[28:29] op_sel_hi:[1,0]
    v_pk_add_f32 v[74:75], v[74:75], v[28:29] op_sel_hi:[1,0]
    v_pk_add_f32 v[76:77], v[76:77], v[28:29] op_sel_hi:[1,0]
    v_pk_add_f32 v[78:79], v[78:79], v[28:29] op_sel_hi:[1,0]
    v_pk_add_f32 v[80:81], v[80:81], v[28:29] op_sel_hi:[1,0]
    v_pk_add_f32 v[82:83], v[82:83], v[28:29] op_sel_hi:[1,0]
    v_pk_mul_f32 v[52:53], v[52:53], s[50:51]
    v_pk_mul_f32 v[54:55], v[54:55], s[50:51]
    v_pk_mul_f32 v[56:57], v[56:57], s[50:51]
    v_pk_mul_f32 v[58:59], v[58:59], s[50:51]
    v_pk_mul_f32 v[60:61], v[60:61], s[50:51]
    v_pk_mul_f32 v[62:63], v[62:63], s[50:51]
    v_pk_mul_f32 v[64:65], v[64:65], s[50:51]
    v_pk_mul_f32 v[66:67], v[66:67], s[50:51]
    v_pk_mul_f32 v[68:69], v[68:69], s[50:51]
    v_pk_mul_f32 v[70:71], v[70:71], s[50:51]
    v_pk_mul_f32 v[72:73], v[72:73], s[50:51]
    v_pk_mul_f32 v[74:75], v[74:75], s[50:51]
    v_pk_mul_f32 v[76:77], v[76:77], s[50:51]
    v_pk_mul_f32 v[78:79], v[78:79], s[50:51]
    v_pk_mul_f32 v[80:81], v[80:81], s[50:51]
    v_pk_mul_f32 v[82:83], v[82:83], s[50:51]
    v_exp_f32 v52, v52
    v_exp_f32 v53, v53
    v_exp_f32 v54, v54
    v_exp_f32 v55, v55
    v_exp_f32 v56, v56
    v_exp_f32 v57, v57
    v_exp_f32 v58, v58
    v_exp_f32 v59, v59
    v_exp_f32 v60, v60
    v_exp_f32 v61, v61
    v_exp_f32 v62, v62
    v_exp_f32 v63, v63
    v_exp_f32 v64, v64
    v_exp_f32 v65, v65
    v_exp_f32 v66, v66
    v_exp_f32 v67, v67
    v_exp_f32 v68, v68
    v_exp_f32 v69, v69
    v_exp_f32 v70, v70
    v_exp_f32 v71, v71
    v_exp_f32 v72, v72
    v_exp_f32 v73, v73
    v_exp_f32 v74, v74
    v_exp_f32 v75, v75
    v_exp_f32 v76, v76
    v_exp_f32 v77, v77
    v_exp_f32 v78, v78
    v_exp_f32 v79, v79
    v_exp_f32 v80, v80
    v_exp_f32 v81, v81
    v_exp_f32 v82, v82
    v_exp_f32 v83, v83
    v_pk_add_f32 v[26:27], v[52:53], v[54:55]
    v_pk_add_f32 v[24:25], v[56:57], v[58:59]
    v_pk_add_f32 v[26:27], v[26:27], v[60:61]
    v_pk_add_f32 v[24:25], v[24:25], v[62:63]
    v_pk_add_f32 v[26:27], v[26:27], v[64:65]
    v_pk_add_f32 v[24:25], v[24:25], v[66:67]
    v_pk_add_f32 v[26:27], v[26:27], v[68:69]
    v_pk_add_f32 v[24:25], v[24:25], v[70:71]
    v_pk_add_f32 v[26:27], v[26:27], v[72:73]
    v_pk_add_f32 v[24:25], v[24:25], v[74:75]
    v_pk_add_f32 v[26:27], v[26:27], v[76:77]
    v_pk_add_f32 v[24:25], v[24:25], v[78:79]
    v_pk_add_f32 v[26:27], v[26:27], v[80:81]
    v_pk_add_f32 v[24:25], v[24:25], v[82:83]
    v_cvt_pk_bf16_f32 v52, v52, v52
    v_cvt_pk_bf16_f32 v53, v53, v53
    v_cvt_pk_bf16_f32 v54, v54, v54
    v_cvt_pk_bf16_f32 v55, v55, v55
    v_cvt_pk_bf16_f32 v56, v56, v56
    v_cvt_pk_bf16_f32 v57, v57, v57
    v_cvt_pk_bf16_f32 v58, v58, v58
    v_cvt_pk_bf16_f32 v59, v59, v59
    v_cvt_pk_bf16_f32 v60, v60, v60
    v_cvt_pk_bf16_f32 v61, v61, v61
    v_cvt_pk_bf16_f32 v62, v62, v62
    v_cvt_pk_bf16_f32 v63, v63, v63
    v_cvt_pk_bf16_f32 v64, v64, v64
    v_cvt_pk_bf16_f32 v65, v65, v65
    v_cvt_pk_bf16_f32 v66, v66, v66
    v_cvt_pk_bf16_f32 v67, v67, v67
    v_cvt_pk_bf16_f32 v68, v68, v68
    v_cvt_pk_bf16_f32 v69, v69, v69
    v_cvt_pk_bf16_f32 v70, v70, v70
    v_cvt_pk_bf16_f32 v71, v71, v71
    v_cvt_pk_bf16_f32 v72, v72, v72
    v_cvt_pk_bf16_f32 v73, v73, v73
    v_cvt_pk_bf16_f32 v74, v74, v74
    v_cvt_pk_bf16_f32 v75, v75, v75
    v_cvt_pk_bf16_f32 v76, v76, v76
    v_cvt_pk_bf16_f32 v77, v77, v77
    v_cvt_pk_bf16_f32 v78, v78, v78
    v_cvt_pk_bf16_f32 v79, v79, v79
    v_cvt_pk_bf16_f32 v80, v80, v80
    v_cvt_pk_bf16_f32 v81, v81, v81
    v_cvt_pk_bf16_f32 v82, v82, v82
    v_cvt_pk_bf16_f32 v83, v83, v83
    v_pk_add_f32 v[26:27], v[26:27], v[24:25]
    v_add_f32 v29, v26, v27
    s_nop 1
    v_add_f32_dpp v29, v29, v29 row_ror:8 row_mask:0xf bank_mask:0xf
    v_mov_b32 v31, v29
    s_nop 1
    v_permlane16_swap_b32 v29, v31
    v_add_f32 v29, v29, v31
    v_mov_b32 v31, v29
    s_nop 1
    v_permlane32_swap_b32 v29, v31
    v_add_f32 v29, v29, v31
    v_lshrrev_b32 v10, 1, v2
    s_lshl_b32 s57, s59, 1
    v_add_u32 v10, s57, v10
    v_mul_u32_u24 v10, 784, v10
    v_and_b32 v11, 1, v2
    v_lshlrev_b32 v11, 4, v11
    v_add_u32 v12, v10, v11
    v_lshl_add_u32 v13, v3, 5, v12
    v_and_b32 v11, 7, v3
    v_lshl_add_u32 v14, v11, 5, v12
    s_mov_b32 s48, 0
    s_mov_b32 s49, -1
    s_cmp_eq_u32 s59, 0
    s_cselect_b32 s50, 1, 0
    s_mov_b32 s51, 0
    v_mov_b32 v18, 0
    v_mov_b32 v19, 0
    v_cndmask_b32 v16, v19, v30, s[50:51]
    v_cndmask_b32 v17, v29, v18, s[48:49]
    s_mov_b32 exec_lo, 1
    s_mov_b32 exec_hi, 1
    ds_write_b128 v10, v[16:19] offset:1792
    s_mov_b64 exec, -1
    v_and_b32 v10, 3, v3
    v_mul_u32_u24 v10, 3, v10
    v_lshrrev_b32 v11, 2, v3
    v_add_u32 v10, v10, v11
    v_mov_b32 v10, v3
    v_mul_u32_u24 v11, 12, v2
    v_add_u32 v10, v10, v11
    v_cmp_le_u32 vcc, 12, v3
    v_mov_b32 v11, 48
    s_nop 0
    v_cndmask_b32 v10, v10, v11, vcc
    v_lshlrev_b32 v15, 4, v10
    v_lshlrev_b32 v12, 4, v0
    s_lshl_b32 s61, s63, 10
    s_add_u32 s61, s61, 851968
    v_mov_b32 v20, 0
    ds_read_b32 v20, v20 offset:912
    s_waitcnt lgkmcnt(0)
    v_readfirstlane_b32 s62, v20
    s_waitcnt lgkmcnt(0)
    s_mul_i32 s7, s6, 0x9E3779B1
    s_add_u32 s7, s7, 0x7F4A7C15
    s_add_u32 s53, s6, 0x55
    s_and_b32 s53, s53, 0x7F
    s_or_b32 s53, s53, 0x80
    v_mov_b32 v11, s53
    s_mov_b32 s57, 0xffffff00
    v_cmp_le_u32 vcc, 12, v3
    v_mov_b32 v24, 0x8000
    v_mov_b32 v25, 0xffff0000
    v_mov_b32 v26, 0xffffff00
    v_cndmask_b32 v24, v24, 0, vcc
    v_cndmask_b32 v25, v25, v26, vcc
    v_and_b32 v32, v52, v6
    v_and_b32 v33, v52, v7
    v_and_b32 v34, v52, v8
    v_and_b32 v35, v52, v9
    s_waitcnt vmcnt(39)
    s_nop 0
    v_mfma_f32_16x16x32_bf16 v[40:43], v[32:35], v[132:135], 0
    v_mfma_f32_16x16x32_bf16 v[44:47], v[32:35], v[136:139], 0
    v_mfma_f32_16x16x32_bf16 v[48:51], v[32:35], v[140:143], 0
    s_mov_b32 s44, 43008
    s_waitcnt vmcnt(23)
    buffer_load_dwordx4 v[132:135], v4, s[36:39], s44 offen nt
    s_waitcnt vmcnt(23)
    buffer_load_dwordx4 v[136:139], v4, s[36:39], s44 offen offset:384 nt
    s_waitcnt vmcnt(23)
    buffer_load_dwordx4 v[140:143], v5, s[36:39], s44 offen nt
    v_and_b32 v36, v53, v6
    v_and_b32 v37, v53, v7
    v_and_b32 v38, v53, v8
    v_and_b32 v39, v53, v9
    s_waitcnt vmcnt(39)
    s_nop 0
    v_mfma_f32_16x16x32_bf16 v[40:43], v[36:39], v[144:147], v[40:43]
    v_mfma_f32_16x16x32_bf16 v[44:47], v[36:39], v[148:151], v[44:47]
    v_mfma_f32_16x16x32_bf16 v[48:51], v[36:39], v[152:155], v[48:51]
    s_mov_b32 s44, 46080
    s_waitcnt vmcnt(23)
    buffer_load_dwordx4 v[144:147], v4, s[36:39], s44 offen nt
    s_waitcnt vmcnt(23)
    buffer_load_dwordx4 v[148:151], v4, s[36:39], s44 offen offset:384 nt
    s_waitcnt vmcnt(23)
    buffer_load_dwordx4 v[152:155], v5, s[36:39], s44 offen nt
    v_and_b32 v32, v54, v6
    v_and_b32 v33, v54, v7
    v_and_b32 v34, v54, v8
    v_and_b32 v35, v54, v9
    s_waitcnt vmcnt(39)
    s_nop 0
    v_mfma_f32_16x16x32_bf16 v[40:43], v[32:35], v[156:159], v[40:43]
    v_mfma_f32_16x16x32_bf16 v[44:47], v[32:35], v[160:163], v[44:47]
    v_mfma_f32_16x16x32_bf16 v[48:51], v[32:35], v[164:167], v[48:51]
    s_mov_b32 s44, 49152
    s_waitcnt vmcnt(23)
    buffer_load_dwordx4 v[156:159], v4, s[36:39], s44 offen nt
    s_waitcnt vmcnt(23)
    buffer_load_dwordx4 v[160:163], v4, s[36:39], s44 offen offset:384 nt
    s_waitcnt vmcnt(23)
    buffer_load_dwordx4 v[164:167], v5, s[36:39], s44 offen nt
    v_and_b32 v36, v55, v6
    v_and_b32 v37, v55, v7
    v_and_b32 v38, v55, v8
    v_and_b32 v39, v55, v9
    s_waitcnt vmcnt(39)
    s_nop 0
    v_mfma_f32_16x16x32_bf16 v[40:43], v[36:39], v[168:171], v[40:43]
    v_mfma_f32_16x16x32_bf16 v[44:47], v[36:39], v[172:175], v[44:47]
    v_mfma_f32_16x16x32_bf16 v[48:51], v[36:39], v[176:179], v[48:51]
    s_mov_b32 s44, 52224
    s_waitcnt vmcnt(23)
    buffer_load_dwordx4 v[168:171], v4, s[36:39], s44 offen nt
    s_waitcnt vmcnt(23)
    buffer_load_dwordx4 v[172:175], v4, s[36:39], s44 offen offset:384 nt
    s_waitcnt vmcnt(23)
    buffer_load_dwordx4 v[176:179], v5, s[36:39], s44 offen nt
    v_and_b32 v32, v56, v6
    v_and_b32 v33, v56, v7
    v_and_b32 v34, v56, v8
    v_and_b32 v35, v56, v9
    s_waitcnt vmcnt(39)
    s_nop 0
    v_mfma_f32_16x16x32_bf16 v[40:43], v[32:35], v[180:183], v[40:43]
    v_mfma_f32_16x16x32_bf16 v[44:47], v[32:35], v[184:187], v[44:47]
    v_mfma_f32_16x16x32_bf16 v[48:51], v[32:35], v[188:191], v[48:51]
    s_mov_b32 s44, 55296
    s_waitcnt vmcnt(23)
    buffer_load_dwordx4 v[180:183], v4, s[36:39], s44 offen nt
    s_waitcnt vmcnt(23)
    buffer_load_dwordx4 v[184:187], v4, s[36:39], s44 offen offset:384 nt
    s_waitcnt vmcnt(23)
    buffer_load_dwordx4 v[188:191], v5, s[36:39], s44 offen nt
    v_and_b32 v36, v57, v6
    v_and_b32 v37, v57, v7
    v_and_b32 v38, v57, v8
    v_and_b32 v39, v57, v9
    s_waitcnt vmcnt(39)
    s_nop 0
    v_mfma_f32_16x16x32_bf16 v[40:43], v[36:39], v[192:195], v[40:43]
    v_mfma_f32_16x16x32_bf16 v[44:47], v[36:39], v[196:199], v[44:47]
    v_mfma_f32_16x16x32_bf16 v[48:51], v[36:39], v[200:203], v[48:51]
    s_mov_b32 s44, 58368
    s_waitcnt vmcnt(23)
    buffer_load_dwordx4 v[192:195], v4, s[36:39], s44 offen nt
    s_waitcnt vmcnt(23)
    buffer_load_dwordx4 v[196:199], v4, s[36:39], s44 offen offset:384 nt
    s_waitcnt vmcnt(23)
    buffer_load_dwordx4 v[200:203], v5, s[36:39], s44 offen nt
    v_and_b32 v32, v58, v6
    v_and_b32 v33, v58, v7
    v_and_b32 v34, v58, v8
    v_and_b32 v35, v58, v9
    s_waitcnt vmcnt(39)
    s_nop 0
    v_mfma_f32_16x16x32_bf16 v[40:43], v[32:35], v[204:207], v[40:43]
    v_mfma_f32_16x16x32_bf16 v[44:47], v[32:35], v[208:211], v[44:47]
    v_mfma_f32_16x16x32_bf16 v[48:51], v[32:35], v[212:215], v[48:51]
    s_mov_b32 s44, 61440
    s_waitcnt vmcnt(23)
    buffer_load_dwordx4 v[204:207], v4, s[36:39], s44 offen nt
    s_waitcnt vmcnt(23)
    buffer_load_dwordx4 v[208:211], v4, s[36:39], s44 offen offset:384 nt
    s_waitcnt vmcnt(23)
    buffer_load_dwordx4 v[212:215], v5, s[36:39], s44 offen nt
    v_and_b32 v36, v59, v6
    v_and_b32 v37, v59, v7
    v_and_b32 v38, v59, v8
    v_and_b32 v39, v59, v9
    s_waitcnt vmcnt(39)
    s_nop 0
    v_mfma_f32_16x16x32_bf16 v[40:43], v[36:39], v[216:219], v[40:43]
    v_mfma_f32_16x16x32_bf16 v[44:47], v[36:39], v[220:223], v[44:47]
    v_mfma_f32_16x16x32_bf16 v[48:51], v[36:39], v[224:227], v[48:51]
    s_mov_b32 s44, 64512
    s_waitcnt vmcnt(23)
    buffer_load_dwordx4 v[216:219], v4, s[36:39], s44 offen nt
    s_waitcnt vmcnt(23)
    buffer_load_dwordx4 v[220:223], v4, s[36:39], s44 offen offset:384 nt
    s_waitcnt vmcnt(23)
    buffer_load_dwordx4 v[224:227], v5, s[36:39], s44 offen nt
    v_and_b32 v32, v60, v6
    v_and_b32 v33, v60, v7
    v_and_b32 v34, v60, v8
    v_and_b32 v35, v60, v9
    s_waitcnt vmcnt(39)
    s_nop 0
    v_mfma_f32_16x16x32_bf16 v[40:43], v[32:35], v[228:231], v[40:43]
    v_mfma_f32_16x16x32_bf16 v[44:47], v[32:35], v[232:235], v[44:47]
    v_mfma_f32_16x16x32_bf16 v[48:51], v[32:35], v[236:239], v[48:51]
    s_mov_b32 s44, 67584
    s_waitcnt vmcnt(23)
    buffer_load_dwordx4 v[228:231], v4, s[36:39], s44 offen nt
    s_waitcnt vmcnt(23)
    buffer_load_dwordx4 v[232:235], v4, s[36:39], s44 offen offset:384 nt
    s_waitcnt vmcnt(23)
    buffer_load_dwordx4 v[236:239], v5, s[36:39], s44 offen nt
    v_and_b32 v36, v61, v6
    v_and_b32 v37, v61, v7
    v_and_b32 v38, v61, v8
    v_and_b32 v39, v61, v9
    s_waitcnt vmcnt(39)
    s_nop 0
    v_mfma_f32_16x16x32_bf16 v[40:43], v[36:39], v[240:243], v[40:43]
    v_mfma_f32_16x16x32_bf16 v[44:47], v[36:39], v[244:247], v[44:47]
    v_mfma_f32_16x16x32_bf16 v[48:51], v[36:39], v[248:251], v[48:51]
    s_mov_b32 s44, 70656
    s_waitcnt vmcnt(23)
    buffer_load_dwordx4 v[240:243], v4, s[36:39], s44 offen nt
    s_waitcnt vmcnt(23)
    buffer_load_dwordx4 v[244:247], v4, s[36:39], s44 offen offset:384 nt
    s_waitcnt vmcnt(23)
    buffer_load_dwordx4 v[248:251], v5, s[36:39], s44 offen nt
    v_and_b32 v32, v62, v6
    v_and_b32 v33, v62, v7
    v_and_b32 v34, v62, v8
    v_and_b32 v35, v62, v9
    s_waitcnt vmcnt(39)
    s_nop 0
    v_mfma_f32_16x16x32_bf16 v[40:43], v[32:35], v[84:87], v[40:43]
    v_mfma_f32_16x16x32_bf16 v[44:47], v[32:35], v[88:91], v[44:47]
    v_mfma_f32_16x16x32_bf16 v[48:51], v[32:35], v[92:95], v[48:51]
    s_mov_b32 s44, 73728
    s_waitcnt vmcnt(23)
    buffer_load_dwordx4 v[84:87], v4, s[36:39], s44 offen nt
    s_waitcnt vmcnt(23)
    buffer_load_dwordx4 v[88:91], v4, s[36:39], s44 offen offset:384 nt
    s_waitcnt vmcnt(23)
    buffer_load_dwordx4 v[92:95], v5, s[36:39], s44 offen nt
    v_and_b32 v36, v63, v6
    v_and_b32 v37, v63, v7
    v_and_b32 v38, v63, v8
    v_and_b32 v39, v63, v9
    s_waitcnt vmcnt(39)
    s_nop 0
    v_mfma_f32_16x16x32_bf16 v[40:43], v[36:39], v[96:99], v[40:43]
    v_mfma_f32_16x16x32_bf16 v[44:47], v[36:39], v[100:103], v[44:47]
    v_mfma_f32_16x16x32_bf16 v[48:51], v[36:39], v[104:107], v[48:51]
    s_mov_b32 s44, 76800
    s_waitcnt vmcnt(23)
    buffer_load_dwordx4 v[96:99], v4, s[36:39], s44 offen nt
    s_waitcnt vmcnt(23)
    buffer_load_dwordx4 v[100:103], v4, s[36:39], s44 offen offset:384 nt
    s_waitcnt vmcnt(23)
    buffer_load_dwordx4 v[104:107], v5, s[36:39], s44 offen nt
    v_and_b32 v32, v64, v6
    v_and_b32 v33, v64, v7
    v_and_b32 v34, v64, v8
    v_and_b32 v35, v64, v9
    s_waitcnt vmcnt(39)
    s_nop 0
    v_mfma_f32_16x16x32_bf16 v[40:43], v[32:35], v[108:111], v[40:43]
    v_mfma_f32_16x16x32_bf16 v[44:47], v[32:35], v[112:115], v[44:47]
    v_mfma_f32_16x16x32_bf16 v[48:51], v[32:35], v[116:119], v[48:51]
    s_mov_b32 s44, 79872
    s_waitcnt vmcnt(23)
    buffer_load_dwordx4 v[108:111], v4, s[36:39], s44 offen nt
    s_waitcnt vmcnt(23)
    buffer_load_dwordx4 v[112:115], v4, s[36:39], s44 offen offset:384 nt
    s_waitcnt vmcnt(23)
    buffer_load_dwordx4 v[116:119], v5, s[36:39], s44 offen nt
    v_and_b32 v36, v65, v6
    v_and_b32 v37, v65, v7
    v_and_b32 v38, v65, v8
    v_and_b32 v39, v65, v9
    s_waitcnt vmcnt(39)
    s_nop 0
    v_mfma_f32_16x16x32_bf16 v[40:43], v[36:39], v[120:123], v[40:43]
    v_mfma_f32_16x16x32_bf16 v[44:47], v[36:39], v[124:127], v[44:47]
    v_mfma_f32_16x16x32_bf16 v[48:51], v[36:39], v[128:131], v[48:51]
    s_mov_b32 s44, 82944
    s_waitcnt vmcnt(23)
    buffer_load_dwordx4 v[120:123], v4, s[36:39], s44 offen nt
    s_waitcnt vmcnt(23)
    buffer_load_dwordx4 v[124:127], v4, s[36:39], s44 offen offset:384 nt
    s_waitcnt vmcnt(23)
    buffer_load_dwordx4 v[128:131], v5, s[36:39], s44 offen nt
    v_and_b32 v32, v66, v6
    v_and_b32 v33, v66, v7
    v_and_b32 v34, v66, v8
    v_and_b32 v35, v66, v9
    s_waitcnt vmcnt(39)
    s_nop 0
    v_mfma_f32_16x16x32_bf16 v[40:43], v[32:35], v[132:135], v[40:43]
    v_mfma_f32_16x16x32_bf16 v[44:47], v[32:35], v[136:139], v[44:47]
    v_mfma_f32_16x16x32_bf16 v[48:51], v[32:35], v[140:143], v[48:51]
    s_mov_b32 s44, 86016
    s_waitcnt vmcnt(23)
    buffer_load_dwordx4 v[132:135], v4, s[36:39], s44 offen nt
    s_waitcnt vmcnt(23)
    buffer_load_dwordx4 v[136:139], v4, s[36:39], s44 offen offset:384 nt
    s_waitcnt vmcnt(23)
    buffer_load_dwordx4 v[140:143], v5, s[36:39], s44 offen nt
    v_and_b32 v36, v67, v6
    v_and_b32 v37, v67, v7
    v_and_b32 v38, v67, v8
    v_and_b32 v39, v67, v9
    s_waitcnt vmcnt(39)
    s_nop 0
    v_mfma_f32_16x16x32_bf16 v[40:43], v[36:39], v[144:147], v[40:43]
    v_mfma_f32_16x16x32_bf16 v[44:47], v[36:39], v[148:151], v[44:47]
    v_mfma_f32_16x16x32_bf16 v[48:51], v[36:39], v[152:155], v[48:51]
    s_mov_b32 s44, 89088
    s_waitcnt vmcnt(23)
    buffer_load_dwordx4 v[144:147], v4, s[36:39], s44 offen nt
    s_waitcnt vmcnt(23)
    buffer_load_dwordx4 v[148:151], v4, s[36:39], s44 offen offset:384 nt
    s_waitcnt vmcnt(23)
    buffer_load_dwordx4 v[152:155], v5, s[36:39], s44 offen nt
    v_and_b32 v32, v68, v6
    v_and_b32 v33, v68, v7
    v_and_b32 v34, v68, v8
    v_and_b32 v35, v68, v9
    s_waitcnt vmcnt(39)
    s_nop 0
    v_mfma_f32_16x16x32_bf16 v[40:43], v[32:35], v[156:159], v[40:43]
    v_mfma_f32_16x16x32_bf16 v[44:47], v[32:35], v[160:163], v[44:47]
    v_mfma_f32_16x16x32_bf16 v[48:51], v[32:35], v[164:167], v[48:51]
    s_mov_b32 s44, 92160
    s_waitcnt vmcnt(23)
    buffer_load_dwordx4 v[156:159], v4, s[36:39], s44 offen nt
    s_waitcnt vmcnt(23)
    buffer_load_dwordx4 v[160:163], v4, s[36:39], s44 offen offset:384 nt
    s_waitcnt vmcnt(23)
    buffer_load_dwordx4 v[164:167], v5, s[36:39], s44 offen nt
    v_and_b32 v36, v69, v6
    v_and_b32 v37, v69, v7
    v_and_b32 v38, v69, v8
    v_and_b32 v39, v69, v9
    s_waitcnt vmcnt(39)
    s_nop 0
    v_mfma_f32_16x16x32_bf16 v[40:43], v[36:39], v[168:171], v[40:43]
    v_mfma_f32_16x16x32_bf16 v[44:47], v[36:39], v[172:175], v[44:47]
    v_mfma_f32_16x16x32_bf16 v[48:51], v[36:39], v[176:179], v[48:51]
    s_mov_b32 s44, 95232
    s_waitcnt vmcnt(23)
    buffer_load_dwordx4 v[168:171], v4, s[36:39], s44 offen nt
    s_waitcnt vmcnt(23)
    buffer_load_dwordx4 v[172:175], v4, s[36:39], s44 offen offset:384 nt
    s_waitcnt vmcnt(23)
    buffer_load_dwordx4 v[176:179], v5, s[36:39], s44 offen nt
    v_and_b32 v32, v70, v6
    v_and_b32 v33, v70, v7
    v_and_b32 v34, v70, v8
    v_and_b32 v35, v70, v9
    s_waitcnt vmcnt(39)
    s_nop 0
    v_mfma_f32_16x16x32_bf16 v[40:43], v[32:35], v[180:183], v[40:43]
    v_mfma_f32_16x16x32_bf16 v[44:47], v[32:35], v[184:187], v[44:47]
    v_mfma_f32_16x16x32_bf16 v[48:51], v[32:35], v[188:191], v[48:51]
    v_and_b32 v36, v71, v6
    v_and_b32 v37, v71, v7
    v_and_b32 v38, v71, v8
    v_and_b32 v39, v71, v9
    s_waitcnt vmcnt(36)
    s_nop 0
    v_mfma_f32_16x16x32_bf16 v[40:43], v[36:39], v[192:195], v[40:43]
    v_mfma_f32_16x16x32_bf16 v[44:47], v[36:39], v[196:199], v[44:47]
    v_mfma_f32_16x16x32_bf16 v[48:51], v[36:39], v[200:203], v[48:51]
    v_and_b32 v32, v72, v6
    v_and_b32 v33, v72, v7
    v_and_b32 v34, v72, v8
    v_and_b32 v35, v72, v9
    s_waitcnt vmcnt(33)
    s_nop 0
    v_mfma_f32_16x16x32_bf16 v[40:43], v[32:35], v[204:207], v[40:43]
    v_mfma_f32_16x16x32_bf16 v[44:47], v[32:35], v[208:211], v[44:47]
    v_mfma_f32_16x16x32_bf16 v[48:51], v[32:35], v[212:215], v[48:51]
    v_and_b32 v36, v73, v6
    v_and_b32 v37, v73, v7
    v_and_b32 v38, v73, v8
    v_and_b32 v39, v73, v9
    s_waitcnt vmcnt(30)
    s_nop 0
    v_mfma_f32_16x16x32_bf16 v[40:43], v[36:39], v[216:219], v[40:43]
    v_mfma_f32_16x16x32_bf16 v[44:47], v[36:39], v[220:223], v[44:47]
    v_mfma_f32_16x16x32_bf16 v[48:51], v[36:39], v[224:227], v[48:51]
    v_and_b32 v32, v74, v6
    v_and_b32 v33, v74, v7
    v_and_b32 v34, v74, v8
    v_and_b32 v35, v74, v9
    s_waitcnt vmcnt(27)
    s_nop 0
    v_mfma_f32_16x16x32_bf16 v[40:43], v[32:35], v[228:231], v[40:43]
    v_mfma_f32_16x16x32_bf16 v[44:47], v[32:35], v[232:235], v[44:47]
    v_mfma_f32_16x16x32_bf16 v[48:51], v[32:35], v[236:239], v[48:51]
    v_and_b32 v36, v75, v6
    v_and_b32 v37, v75, v7
    v_and_b32 v38, v75, v8
    v_and_b32 v39, v75, v9
    s_waitcnt vmcnt(24)
    s_nop 0
    v_mfma_f32_16x16x32_bf16 v[40:43], v[36:39], v[240:243], v[40:43]
    v_mfma_f32_16x16x32_bf16 v[44:47], v[36:39], v[244:247], v[44:47]
    v_mfma_f32_16x16x32_bf16 v[48:51], v[36:39], v[248:251], v[48:51]
    v_and_b32 v32, v76, v6
    v_and_b32 v33, v76, v7
    v_and_b32 v34, v76, v8
    v_and_b32 v35, v76, v9
    s_waitcnt vmcnt(21)
    s_nop 0
    v_mfma_f32_16x16x32_bf16 v[40:43], v[32:35], v[84:87], v[40:43]
    v_mfma_f32_16x16x32_bf16 v[44:47], v[32:35], v[88:91], v[44:47]
    v_mfma_f32_16x16x32_bf16 v[48:51], v[32:35], v[92:95], v[48:51]
    v_and_b32 v36, v77, v6
    v_and_b32 v37, v77, v7
    v_and_b32 v38, v77, v8
    v_and_b32 v39, v77, v9
    s_waitcnt vmcnt(18)
    s_nop 0
    v_mfma_f32_16x16x32_bf16 v[40:43], v[36:39], v[96:99], v[40:43]
    v_mfma_f32_16x16x32_bf16 v[44:47], v[36:39], v[100:103], v[44:47]
    v_mfma_f32_16x16x32_bf16 v[48:51], v[36:39], v[104:107], v[48:51]
    v_and_b32 v32, v78, v6
    v_and_b32 v33, v78, v7
    v_and_b32 v34, v78, v8
    v_and_b32 v35, v78, v9
    s_waitcnt vmcnt(15)
    s_nop 0
    v_mfma_f32_16x16x32_bf16 v[40:43], v[32:35], v[108:111], v[40:43]
    v_mfma_f32_16x16x32_bf16 v[44:47], v[32:35], v[112:115], v[44:47]
    v_mfma_f32_16x16x32_bf16 v[48:51], v[32:35], v[116:119], v[48:51]
    v_and_b32 v36, v79, v6
    v_and_b32 v37, v79, v7
    v_and_b32 v38, v79, v8
    v_and_b32 v39, v79, v9
    s_waitcnt vmcnt(12)
    s_nop 0
    v_mfma_f32_16x16x32_bf16 v[40:43], v[36:39], v[120:123], v[40:43]
    v_mfma_f32_16x16x32_bf16 v[44:47], v[36:39], v[124:127], v[44:47]
    v_mfma_f32_16x16x32_bf16 v[48:51], v[36:39], v[128:131], v[48:51]
    v_and_b32 v32, v80, v6
    v_and_b32 v33, v80, v7
    v_and_b32 v34, v80, v8
    v_and_b32 v35, v80, v9
    s_waitcnt vmcnt(9)
    s_nop 0
    v_mfma_f32_16x16x32_bf16 v[40:43], v[32:35], v[132:135], v[40:43]
    v_mfma_f32_16x16x32_bf16 v[44:47], v[32:35], v[136:139], v[44:47]
    v_mfma_f32_16x16x32_bf16 v[48:51], v[32:35], v[140:143], v[48:51]
    v_and_b32 v36, v81, v6
    v_and_b32 v37, v81, v7
    v_and_b32 v38, v81, v8
    v_and_b32 v39, v81, v9
    s_waitcnt vmcnt(6)
    s_nop 0
    v_mfma_f32_16x16x32_bf16 v[40:43], v[36:39], v[144:147], v[40:43]
    v_mfma_f32_16x16x32_bf16 v[44:47], v[36:39], v[148:151], v[44:47]
    v_mfma_f32_16x16x32_bf16 v[48:51], v[36:39], v[152:155], v[48:51]
    v_and_b32 v32, v82, v6
    v_and_b32 v33, v82, v7
    v_and_b32 v34, v82, v8
    v_and_b32 v35, v82, v9
    s_waitcnt vmcnt(3)
    s_nop 0
    v_mfma_f32_16x16x32_bf16 v[40:43], v[32:35], v[156:159], v[40:43]
    v_mfma_f32_16x16x32_bf16 v[44:47], v[32:35], v[160:163], v[44:47]
    v_mfma_f32_16x16x32_bf16 v[48:51], v[32:35], v[164:167], v[48:51]
    v_and_b32 v36, v83, v6
    v_and_b32 v37, v83, v7
    v_and_b32 v38, v83, v8
    v_and_b32 v39, v83, v9
    s_waitcnt vmcnt(0)
    s_nop 0
    v_mfma_f32_16x16x32_bf16 v[40:43], v[36:39], v[168:171], v[40:43]
    v_mfma_f32_16x16x32_bf16 v[44:47], v[36:39], v[172:175], v[44:47]
    v_mfma_f32_16x16x32_bf16 v[48:51], v[36:39], v[176:179], v[48:51]
L_Tjoin:
    s_nop 6
    v_cndmask_b32 v20, v40, v44, s[48:49]
    v_cndmask_b32 v21, v41, v45, s[48:49]
    v_cndmask_b32 v22, v42, v46, s[48:49]
    v_cndmask_b32 v23, v43, v47, s[48:49]
    ds_write_b128 v13, v[20:23] offset:1024
    s_mov_b32 exec_lo, 0x00ff00ff
    s_mov_b32 exec_hi, 0xff00ff00
    ds_write_b128 v14, v[48:51] offset:1536
    s_mov_b64 exec, -1
    s_waitcnt lgkmcnt(0)
    s_barrier
    s_cmp_eq_u32 s59, 0
    s_cbranch_scc1 L_T0
    s_endpgm
L_T0:
    ds_read_b128 v[84:87], v15 offset:1024
    ds_read_b128 v[88:91], v15 offset:1808
    ds_read_b128 v[92:95], v15 offset:2592
    ds_read_b128 v[96:99], v15 offset:3376
    ds_read_b128 v[100:103], v15 offset:4160
    ds_read_b128 v[104:107], v15 offset:4944
    ds_read_b128 v[108:111], v15 offset:5728
    ds_read_b128 v[112:115], v15 offset:6512
    s_waitcnt lgkmcnt(6)
    v_pk_add_f32 v[84:85], v[84:85], v[88:89]
    v_pk_add_f32 v[86:87], v[86:87], v[90:91]
    s_waitcnt lgkmcnt(4)
    v_pk_add_f32 v[92:93], v[92:93], v[96:97]
    v_pk_add_f32 v[94:95], v[94:95], v[98:99]
    s_waitcnt lgkmcnt(2)
    v_pk_add_f32 v[100:101], v[100:101], v[104:105]
    v_pk_add_f32 v[102:103], v[102:103], v[106:107]
    s_waitcnt lgkmcnt(0)
    v_pk_add_f32 v[108:109], v[108:109], v[112:113]
    v_pk_add_f32 v[110:111], v[110:111], v[114:115]
    v_pk_add_f32 v[84:85], v[84:85], v[92:93]
    v_pk_add_f32 v[86:87], v[86:87], v[94:95]
    v_pk_add_f32 v[100:101], v[100:101], v[108:109]
    v_pk_add_f32 v[102:103], v[102:103], v[110:111]
    v_pk_add_f32 v[84:85], v[84:85], v[100:101]
    v_pk_add_f32 v[86:87], v[86:87], v[102:103]
    v_add_u32 v84, v84, v24
    v_add_u32 v85, v85, v24
    v_add_u32 v86, v86, v24
    v_add_u32 v87, v87, v24
    v_and_or_b32 v84, v84, v25, v11
    v_and_or_b32 v85, v85, v25, v11
    v_and_or_b32 v86, v86, v25, v11
    v_and_or_b32 v87, v87, v25, v11
    s_cmp_eq_u32 s62, 1
    s_cbranch_scc1 L_Oloc
    buffer_store_dwordx4 v[84:87], v12, s[40:43], s61 offen sc1
    s_branch L_Odone
L_Oloc:
    buffer_store_dwordx4 v[84:87], v12, s[40:43], s61 offen
L_Odone:
    s_waitcnt vmcnt(0)
    s_endpgm
L_end:
    s_endpgm

.section .rodata,"a"
.p2align 6
.amdhsa_kernel parallel_sum__mha_block_cached__geglu_ffn__decode_kernel
  .amdhsa_next_free_vgpr 256
  .amdhsa_next_free_sgpr 102
  .amdhsa_accum_offset 256
  .amdhsa_group_segment_fixed_size 0
  .amdhsa_kernarg_size 96
  .amdhsa_user_sgpr_count 2
  .amdhsa_user_sgpr_kernarg_segment_ptr 1
  .amdhsa_system_sgpr_workgroup_id_x 1
  .amdhsa_float_denorm_mode_32 3
.end_amdhsa_kernel
```
